```python
import torch

def _softmax(x, axis=-1):
    return torch.softmax(x, dim=axis)
def _gelu(x):
    return torch.nn.functional.gelu(x, approximate="tanh")
def _silu(x):
    return torch.nn.functional.silu(x)
def _sigmoid(x):
    return torch.sigmoid(x)
def _layernorm(x, axis=-1, eps=1e-5):
    m = x.mean(dim=axis, keepdim=True)
    v = x.var(dim=axis, keepdim=True, unbiased=False)
    return (x - m) / torch.sqrt(v + eps)
def _scatter_add(tgt, idx, src, axis=0):
    return tgt.clone().index_add_(axis, idx, src)
def _segment_sum(src, seg, n):
    out = torch.zeros((n,) + src.shape[1:], dtype=src.dtype)
    return out.index_add_(0, seg, src)
def _pad(x, pw):
    flat = tuple(v for pair in reversed(pw) for v in pair)
    return torch.nn.functional.pad(x, flat)

kernel_name = 'sequential_preLN__linear_attn_block__glu_gated_glu__prompt'

def setup_inputs():

    _w = (lambda a: (lambda t: t.to(torch.bfloat16) if t.is_floating_point() else t)(torch.as_tensor(a)))
    def _A_setup():
        B, S, D = 1, 2048, 448
        return {
            "x": _w((lambda *s: torch.randn(*s, dtype=torch.bfloat16) * 0.05)(B, S, D)),
            "wqkv": _w((lambda *s: torch.randn(*s, dtype=torch.bfloat16) * 0.1)(D, 3 * D)),
            "wo": _w((lambda *s: torch.randn(*s, dtype=torch.bfloat16) * 0.05)(D, D)),
        }
    _A_in = _A_setup()

    def _B_setup():
        B, S, D, F = 1, 2048, 448, 1792
        return {
            "x": _w((lambda *s: torch.randn(*s, dtype=torch.bfloat16) * 0.05)(B, S, D)),
            "w_gate": _w((lambda *s: torch.randn(*s, dtype=torch.bfloat16) * 0.05)(D, F)),
            "w_up": _w((lambda *s: torch.randn(*s, dtype=torch.bfloat16) * 0.05)(D, F)),
            "w_down": _w((lambda *s: torch.randn(*s, dtype=torch.bfloat16) * 0.05)(F, D)),
        }
    _B_in = _B_setup()

    return {
        "A_x": _A_in["x"],
        "A_wqkv": _A_in["wqkv"],
        "A_wo": _A_in["wo"],
        "B_x": _B_in["x"],
        "B_w_gate": _B_in["w_gate"],
        "B_w_up": _B_in["w_up"],
        "B_w_down": _B_in["w_down"],
    }

def reference(A_x, A_wqkv, A_wo, B_x, B_w_gate, B_w_up, B_w_down):
    def _A_ref(x, wqkv, wo):
        B, S, D = x.shape
        H = 16; Dh = D // H
        qkv = (lambda x, *d: x.permute(*d))((x @ wqkv).reshape(B, S, 3, H, Dh), 2, 0, 3, 1, 4)
        q, k, v = qkv[0], qkv[1], qkv[2]
        phi = lambda t: torch.where(t > 0, t + 1, torch.exp(t)) + 1e-6
        pq, pk = phi(q), phi(k)
        kv = torch.einsum("bhsd,bhse->bhde", pk, v)
        z = torch.einsum("bhsd->bhd", pk)
        num = torch.einsum("bhqd,bhde->bhqe", pq, kv)
        den = torch.einsum("bhqd,bhd->bhq", pq, z)[..., None] + 1e-6
        o = num / den
        return (lambda x, *d: x.permute(*d))(o, 0, 2, 1, 3).reshape(B, S, D) @ wo

    def _B_ref(x, w_gate, w_up, w_down):
        g = torch.einsum("bsd,df->bsf", x, w_gate)
        u = torch.einsum("bsd,df->bsf", x, w_up)
        h = _sigmoid(g) * u
        return torch.einsum("bsf,fd->bsd", h, w_down)

    x = A_x
    h = x + _A_ref(_layernorm(x, axis=-1), A_wqkv, A_wo)
    h2 = h + _B_ref(_layernorm(h, axis=-1), B_w_gate, B_w_up, B_w_down)
    return h2
```

```asm
; @launch grid=(256,1,1) block=(256,1,1) lds=163840
.amdgcn_target "amdgcn-amd-amdhsa--gfx950"
.text
.globl sequential_preLN__linear_attn_block__glu_gated_glu__prompt_kernel
.p2align 8
.type sequential_preLN__linear_attn_block__glu_gated_glu__prompt_kernel,@function
sequential_preLN__linear_attn_block__glu_gated_glu__prompt_kernel:
    s_cmpk_ge_u32 s2, 256
    s_cbranch_scc1 L_end
    s_load_dwordx4 s[4:7], s[0:1], 0
    s_load_dwordx2 s[32:33], s[0:1], 16
    s_load_dwordx8 s[8:15], s[0:1], 32
    s_load_dwordx4 s[20:23], s[0:1], 64
    v_lshrrev_b32 v26, 6, v0
    v_and_b32 v0, 63, v0
    v_readfirstlane_b32 s62, v26
    s_lshr_b32 s77, s2, 3
    s_getpc_b64 s[72:73]
L_pc:
    s_mov_b32 s74, L_end-L_pc
    s_mov_b32 s75, 0x20000
    s_lshl2_add_u32 s3, s77, s62
    s_lshl_b32 s3, s3, 9
    v_and_b32 v29, 3, v0
    v_lshlrev_b32 v29, 7, v29
    buffer_load_dword v31, v29, s[72:75], s3 offen
    s_bfe_u32 s3, s2, 0x20001
    s_and_b32 s18, s77, 3
    s_lshr_b32 s63, s77, 2
    s_lshl2_add_u32 s60, s3, s18
    s_lshl1_add_u32 s70, s18, s63
    s_add_u32 s70, s70, s3
    s_mul_i32 s3, s70, 37
    s_lshr_b32 s3, s3, 8
    s_mul_i32 s3, s3, 7
    s_sub_u32 s70, s70, s3
    v_lshrrev_b32 v240, 3, v0
    v_and_b32 v241, 7, v0
    v_lshrrev_b32 v242, 4, v0
    s_lshl2_add_u32 s3, s60, s62
    s_mul_i32 s3, s3, 28672
    v_mul_u32_u24 v26, 896, v240
    v_xor_b32 v27, v241, v242
    v_add_u32 v26, s3, v26
    v_lshl_add_u32 v5, v27, 4, v26
    v_xor_b32 v27, 4, v27
    v_lshl_add_u32 v6, v27, 4, v26
    v_add_u32 v7, 12288, v5
    v_add_u32 v8, 18432, v6
    v_add_u32 v6, 6144, v6
    s_mul_i32 s57, s62, 28672
    s_add_u32 s57, s57, 49152
    s_mov_b32 s26, 1835008
    s_mov_b32 s27, 0x20000
    s_waitcnt lgkmcnt(0)
    s_mov_b32 s24, s4
    s_mov_b32 s25, s5
    s_add_u32 m0, s57, 0
    s_lshl_b32 s56, s70, 7
    buffer_load_dwordx4 v5, s[24:27], s56 offen lds
    buffer_load_dwordx4 v6, s[24:27], s56 offen offset:1024 lds
    buffer_load_dwordx4 v7, s[24:27], s56 offen offset:2048 lds
    buffer_load_dwordx4 v8, s[24:27], s56 offen offset:3072 lds
    s_add_u32 s71, s70, 1
    s_cmp_ge_u32 s71, 7
    s_cselect_b32 s71, 0, s71
    s_lshl2_add_u32 s3, s2, s62
    s_lshr_b32 s16, s3, 1
    s_mul_i32 s16, s16, 2688
    s_and_b32 s3, s3, 1
    s_mul_i32 s3, s3, 896
    s_add_u32 s16, s16, s3
    v_min_u32 v46, 6, v0
    v_lshlrev_b32 v46, 7, v46
    s_mov_b32 s30, 1204224
    s_mov_b32 s31, 0x20000
    s_mov_b32 s28, s6
    s_mov_b32 s29, s7
    buffer_load_dword a249, v46, s[28:31], s16 offen offset:896
    s_add_u32 m0, s57, 4096
    s_lshl_b32 s56, s71, 7
    buffer_load_dwordx4 v5, s[24:27], s56 offen lds
    buffer_load_dwordx4 v6, s[24:27], s56 offen offset:1024 lds
    buffer_load_dwordx4 v7, s[24:27], s56 offen offset:2048 lds
    buffer_load_dwordx4 v8, s[24:27], s56 offen offset:3072 lds
    s_add_u32 s72, s71, 1
    s_cmp_ge_u32 s72, 7
    s_cselect_b32 s72, 0, s72
    s_add_u32 s73, s72, 1
    s_cmp_ge_u32 s73, 7
    s_cselect_b32 s73, 0, s73
    s_add_u32 s74, s73, 1
    s_cmp_ge_u32 s74, 7
    s_cselect_b32 s74, 0, s74
    s_add_u32 s75, s74, 1
    s_cmp_ge_u32 s75, 7
    s_cselect_b32 s75, 0, s75
    s_add_u32 s76, s75, 1
    s_cmp_ge_u32 s76, 7
    s_cselect_b32 s76, 0, s76
    s_and_b32 s65, s2, 1
    s_lshl3_add_u32 s61, s65, s63
    s_sub_u32 s66, s61, s65
    s_lshl_b32 s64, s62, 10
    s_lshl_b32 s69, s60, 13
    s_and_b32 s67, s62, 1
    s_lshr_b32 s68, s62, 1
    s_mov_b32 s28, s6
    s_mov_b32 s29, s7
    s_cmp_lt_u32 s62, 2
    s_cselect_b32 s36, s8, s10
    s_cselect_b32 s37, s9, s11
    s_mov_b32 s40, s12
    s_mov_b32 s41, s13
    s_mov_b32 s44, s14
    s_mov_b32 s45, s15
    s_mov_b32 s52, s20
    s_mov_b32 s53, s21
    s_mov_b32 s48, s22
    s_mov_b32 s49, s23
    s_cmp_lt_u32 s63, 7
    s_cselect_b32 s34, 401408, 0
    s_cselect_b32 s38, 1605632, 0
    s_lshl1_add_u32 s22, s65, s67
    s_mov_b32 s30, 0x126000
    s_mov_b32 s31, 0x20000
    s_mov_b32 s35, 0x20000
    s_mov_b32 s42, 0x188000
    s_mov_b32 s43, 0x20000
    s_mov_b32 s39, 0x20000
    s_mov_b32 s46, 0x1c0000
    s_mov_b32 s47, 0x20000
    s_mov_b32 s54, 0x100
    s_mov_b32 s55, 0x20000
    s_mov_b32 s50, 0xd00000
    s_mov_b32 s51, 0x20000
    v_lshlrev_b32 v1, 4, v0
    v_lshlrev_b32 v4, 3, v0
    v_mov_b32 v2, 1
    v_and_b32 v243, 31, v0
    v_lshrrev_b32 v244, 5, v0
    v_bfe_u32 v245, v0, 2, 2
    v_and_b32 v246, 3, v0
    v_bfe_u32 v247, v0, 4, 1
    s_cmp_eq_u32 s61, 15
    s_cselect_b32 s3, 1, 0
    s_cmp_eq_u32 s62, 0
    s_cselect_b32 s23, s3, 0
    s_cmp_eq_u32 s23, 0
    s_cbranch_scc1 L_nozero
    v_lshlrev_b32 v29, 7, v0
    v_mov_b32 v30, 0
    buffer_store_dword v30, v29, s[48:51], s69 offen sc1
L_nozero:
    v_cmp_lt_u32 s[14:15], 31, v0
    v_cmp_eq_u32 s[16:17], 28, v243
    v_lshlrev_b32 v26, 7, v243
    v_add_u32 v26, s57, v26
    v_bfe_u32 v27, v0, 1, 3
    v_xor_b32 v27, v27, v244
    v_xor_b32 v28, 0, v27
    v_lshl_add_u32 v9, v28, 4, v26
    v_xor_b32 v28, 2, v27
    v_lshl_add_u32 v10, v28, 4, v26
    v_xor_b32 v28, 4, v27
    v_lshl_add_u32 v11, v28, 4, v26
    v_xor_b32 v28, 6, v27
    v_lshl_add_u32 v12, v28, 4, v26
    v_lshlrev_b32 v26, 2, v247
    v_xor_b32 v26, v26, v241
    v_lshlrev_b32 v30, 4, v26
    v_lshrrev_b32 v27, 2, v26
    v_and_b32 v26, 3, v26
    v_lshlrev_b32 v28, 1, v26
    v_min_u32 v28, 5, v28
    v_lshlrev_b32 v28, 3, v28
    s_movk_i32 s56, 896
    v_mad_u32_u24 v28, v27, s56, v28
    v_mad_u32_u24 v30, v240, s56, v30
    s_lshl_b32 s3, s62, 3
    v_add_u32 v29, s3, v240
    s_movk_i32 s56, 2688
    v_mad_u32_u24 v28, v29, s56, v28
    s_mul_i32 s3, s61, 56
    s_add_u32 s4, s3, 896
    v_add_u32 v13, s4, v28
    s_lshl_b32 s6, s63, 7
    s_mul_i32 s4, s62, 7168
    s_add_u32 s4, s4, s6
    v_add_u32 v18, s4, v30
    s_mul_i32 s4, s68, 802816
    s_mul_i32 s5, s67, 7168
    s_add_u32 s4, s4, s5
    s_add_u32 s4, s4, s6
    v_add_u32 v21, s4, v30
    v_lshlrev_b32 v28, 1, v246
    v_min_u32 v28, 5, v28
    v_lshlrev_b32 v28, 3, v28
    v_lshrrev_b32 v29, 2, v0
    v_mul_u32_u24 v30, 896, v29
    s_lshl_b32 s4, s62, 4
    v_add_u32 v29, s4, v29
    v_mad_u32_u24 v28, v29, s56, v28
    v_add_u32 v16, s3, v28
    s_lshl2_add_u32 s4, s60, s22
    s_mul_i32 s4, s4, 28672
    s_add_u32 s4, s4, s6
    s_lshl_b32 s5, s68, 6
    s_add_u32 s4, s4, s5
    v_lshl_add_u32 v30, v246, 4, v30
    v_add_u32 v19, s4, v30
    v_lshlrev_b32 v26, 3, v246
    v_lshl_add_u32 v26, v247, 5, v26
    v_lshrrev_b32 v27, 1, v246
    v_and_b32 v27, v27, v247
    v_lshlrev_b32 v27, 3, v27
    v_xor_b32 v27, v26, v27
    v_lshrrev_b32 v28, 1, v245
    v_lshlrev_b32 v28, 6, v28
    v_lshl_add_u32 v29, v244, 3, v245
    v_xor_b32 v30, v27, v28
    v_lshl_add_u32 v14, v29, 7, v30
    v_xor_b32 v15, 64, v14
    v_lshl_add_u32 v17, v29, 6, v27
    v_add_u32 v17, 57344, v17
    v_xor_b32 v30, v26, v28
    s_lshl_b32 s3, s68, 6
    v_xor_b32 v30, s3, v30
    v_lshl_add_u32 v30, v245, 7, v30
    s_mul_i32 s3, s68, 28672
    v_add_u32 v24, s3, v30
    v_xor_b32 v25, 64, v24
    v_lshl_add_u32 v22, v244, 9, v24
    v_xor_b32 v23, 64, v22
    s_lshl_b32 s4, s68, 2
    v_lshl_add_u32 v26, v247, 1, s4
    v_xor_b32 v26, v26, v241
    v_lshlrev_b32 v26, 4, v26
    s_movk_i32 s56, 3584
    v_mad_u32_u24 v26, v240, s56, v26
    s_mul_i32 s4, s67, 28672
    s_lshl_b32 s5, s66, 8
    s_add_u32 s4, s4, s5
    v_add_u32 v20, s4, v26
    s_mul_i32 s3, s77, 14
    s_lshl2_add_u32 s3, s62, s3
    s_mul_i32 s3, s3, 2688
    s_mul_i32 s4, s65, 384
    s_add_u32 s3, s3, s4
    v_mul_u32_u24 v26, 2688, v242
    v_bfe_u32 v27, v0, 2, 2
    v_min_u32 v27, 2, v27
    v_mul_u32_u24 v27, 896, v27
    v_and_b32 v28, 3, v0
    v_lshl_add_u32 v27, v28, 7, v27
    v_add3_u32 v45, v26, v27, s3
    s_add_u32 s3, s63, 1
    s_lshr_b32 s3, s3, 1
    s_mul_i32 s4, s18, 5
    s_add_u32 s3, s3, s4
    s_lshl1_add_u32 s4, s3, s67
    s_mul_i32 s4, s4, 3
    s_bfe_u32 s5, s2, 0x20001
    s_mul_i32 s5, s5, 112
    s_add_u32 s4, s4, s5
    s_mul_i32 s4, s4, 3584
    s_mul_i32 s5, s65, 1792
    s_add_u32 s4, s4, s5
    v_min_u32 v26, 2, v242
    v_mul_u32_u24 v26, 3584, v26
    v_and_b32 v27, 14, v0
    v_min_u32 v27, 12, v27
    v_lshl_add_u32 v26, v27, 7, v26
    v_add_u32 v32, s4, v26
    v_min_u32 v27, 6, v241
    s_lshl2_add_u32 s3, s3, s62
    s_min_u32 s3, s3, 55
    s_and_b32 s4, s2, 7
    s_mul_i32 s4, s4, 56
    s_add_u32 s3, s3, s4
    s_mul_i32 s3, s3, 896
    v_lshlrev_b32 v27, 7, v27
    v_add_u32 v33, s3, v27
    s_mul_i32 s3, s65, 42
    s_add_u32 s3, s3, 0xab
    s_lshr_b32 s3, s3, s63
    s_and_b32 s19, s3, 1
    v_mov_b32 v248, 0
    v_mov_b32 v249, 0
    v_mov_b32 v250, 0x3f803f80
    v_mov_b32 v251, 0x3f803f80
    s_lshl_b32 s3, s62, 8
    s_add_u32 s3, s3, 104448
    v_lshl_add_u32 v29, v243, 2, s3
    v_lshl_add_u32 v30, v244, 4, s3
    s_add_u32 m0, s57, 8192
    s_lshl_b32 s56, s72, 7
    buffer_load_dwordx4 v5, s[24:27], s56 offen lds
    buffer_load_dwordx4 v6, s[24:27], s56 offen offset:1024 lds
    buffer_load_dwordx4 v7, s[24:27], s56 offen offset:2048 lds
    buffer_load_dwordx4 v8, s[24:27], s56 offen offset:3072 lds
    s_waitcnt vmcnt(9)
    ds_read_b128 v[128:131], v9 offset:0
    ds_read_b128 v[132:135], v10 offset:0
    ds_read_b128 v[136:139], v11 offset:0
    ds_read_b128 v[140:143], v12 offset:0
    s_add_u32 m0, s57, 12288
    s_lshl_b32 s56, s73, 7
    buffer_load_dwordx4 v5, s[24:27], s56 offen lds
    buffer_load_dwordx4 v6, s[24:27], s56 offen offset:1024 lds
    buffer_load_dwordx4 v7, s[24:27], s56 offen offset:2048 lds
    buffer_load_dwordx4 v8, s[24:27], s56 offen offset:3072 lds
    s_waitcnt vmcnt(8)
    ds_read_b128 v[144:147], v9 offset:4096
    ds_read_b128 v[148:151], v10 offset:4096
    ds_read_b128 v[152:155], v11 offset:4096
    ds_read_b128 v[156:159], v12 offset:4096
    s_add_u32 m0, s57, 16384
    s_lshl_b32 s56, s74, 7
    buffer_load_dwordx4 v5, s[24:27], s56 offen lds
    s_waitcnt lgkmcnt(7)
    v_dot2c_f32_bf16 v248, v128, v250
    v_dot2c_f32_bf16 v249, v128, v128
    v_dot2c_f32_bf16 v248, v129, v250
    v_dot2c_f32_bf16 v249, v129, v129
    v_dot2c_f32_bf16 v248, v130, v250
    v_dot2c_f32_bf16 v249, v130, v130
    v_dot2c_f32_bf16 v248, v131, v250
    v_dot2c_f32_bf16 v249, v131, v131
    buffer_load_dwordx4 v6, s[24:27], s56 offen offset:1024 lds
    s_waitcnt lgkmcnt(6)
    v_dot2c_f32_bf16 v248, v132, v250
    v_dot2c_f32_bf16 v249, v132, v132
    v_dot2c_f32_bf16 v248, v133, v250
    v_dot2c_f32_bf16 v249, v133, v133
    v_dot2c_f32_bf16 v248, v134, v250
    v_dot2c_f32_bf16 v249, v134, v134
    v_dot2c_f32_bf16 v248, v135, v250
    v_dot2c_f32_bf16 v249, v135, v135
    buffer_load_dwordx4 v7, s[24:27], s56 offen offset:2048 lds
    s_waitcnt lgkmcnt(5)
    v_dot2c_f32_bf16 v248, v136, v250
    v_dot2c_f32_bf16 v249, v136, v136
    v_dot2c_f32_bf16 v248, v137, v250
    v_dot2c_f32_bf16 v249, v137, v137
    v_dot2c_f32_bf16 v248, v138, v250
    v_dot2c_f32_bf16 v249, v138, v138
    v_dot2c_f32_bf16 v248, v139, v250
    v_dot2c_f32_bf16 v249, v139, v139
    buffer_load_dwordx4 v8, s[24:27], s56 offen offset:3072 lds
    s_waitcnt lgkmcnt(4)
    v_dot2c_f32_bf16 v248, v140, v250
    v_dot2c_f32_bf16 v249, v140, v140
    v_dot2c_f32_bf16 v248, v141, v250
    v_dot2c_f32_bf16 v249, v141, v141
    v_dot2c_f32_bf16 v248, v142, v250
    v_dot2c_f32_bf16 v249, v142, v142
    v_dot2c_f32_bf16 v248, v143, v250
    v_dot2c_f32_bf16 v249, v143, v143
    s_waitcnt vmcnt(8)
    s_cmp_eq_u32 s23, 0
    s_cbranch_scc1 L_nozero2
    s_mov_b64 exec, 1
    buffer_atomic_add v2, off, s[52:55], 0
    s_mov_b64 exec, -1
L_nozero2:
    ds_read_b128 v[160:163], v9 offset:8192
    ds_read_b128 v[164:167], v10 offset:8192
    ds_read_b128 v[168:171], v11 offset:8192
    ds_read_b128 v[172:175], v12 offset:8192
    s_add_u32 m0, s57, 20480
    s_lshl_b32 s56, s75, 7
    buffer_load_dwordx4 v5, s[24:27], s56 offen lds
    s_waitcnt lgkmcnt(7)
    v_dot2c_f32_bf16 v248, v144, v250
    v_dot2c_f32_bf16 v249, v144, v144
    v_dot2c_f32_bf16 v248, v145, v250
    v_dot2c_f32_bf16 v249, v145, v145
    v_dot2c_f32_bf16 v248, v146, v250
    v_dot2c_f32_bf16 v249, v146, v146
    v_dot2c_f32_bf16 v248, v147, v250
    v_dot2c_f32_bf16 v249, v147, v147
    buffer_load_dwordx4 v6, s[24:27], s56 offen offset:1024 lds
    s_waitcnt lgkmcnt(6)
    v_dot2c_f32_bf16 v248, v148, v250
    v_dot2c_f32_bf16 v249, v148, v148
    v_dot2c_f32_bf16 v248, v149, v250
    v_dot2c_f32_bf16 v249, v149, v149
    v_dot2c_f32_bf16 v248, v150, v250
    v_dot2c_f32_bf16 v249, v150, v150
    v_dot2c_f32_bf16 v248, v151, v250
    v_dot2c_f32_bf16 v249, v151, v151
    buffer_load_dwordx4 v7, s[24:27], s56 offen offset:2048 lds
    s_waitcnt lgkmcnt(5)
    v_dot2c_f32_bf16 v248, v152, v250
    v_dot2c_f32_bf16 v249, v152, v152
    v_dot2c_f32_bf16 v248, v153, v250
    v_dot2c_f32_bf16 v249, v153, v153
    v_dot2c_f32_bf16 v248, v154, v250
    v_dot2c_f32_bf16 v249, v154, v154
    v_dot2c_f32_bf16 v248, v155, v250
    v_dot2c_f32_bf16 v249, v155, v155
    buffer_load_dwordx4 v8, s[24:27], s56 offen offset:3072 lds
    s_waitcnt lgkmcnt(4)
    v_dot2c_f32_bf16 v248, v156, v250
    v_dot2c_f32_bf16 v249, v156, v156
    v_dot2c_f32_bf16 v248, v157, v250
    v_dot2c_f32_bf16 v249, v157, v157
    v_dot2c_f32_bf16 v248, v158, v250
    v_dot2c_f32_bf16 v249, v158, v158
    v_dot2c_f32_bf16 v248, v159, v250
    v_dot2c_f32_bf16 v249, v159, v159
    s_waitcnt vmcnt(8)
    ds_read_b128 v[176:179], v9 offset:12288
    ds_read_b128 v[180:183], v10 offset:12288
    ds_read_b128 v[184:187], v11 offset:12288
    ds_read_b128 v[188:191], v12 offset:12288
    s_add_u32 m0, s57, 24576
    s_lshl_b32 s56, s76, 7
    buffer_load_dwordx4 v5, s[24:27], s56 offen lds
    s_waitcnt lgkmcnt(7)
    v_dot2c_f32_bf16 v248, v160, v250
    v_dot2c_f32_bf16 v249, v160, v160
    v_dot2c_f32_bf16 v248, v161, v250
    v_dot2c_f32_bf16 v249, v161, v161
    v_dot2c_f32_bf16 v248, v162, v250
    v_dot2c_f32_bf16 v249, v162, v162
    v_dot2c_f32_bf16 v248, v163, v250
    v_dot2c_f32_bf16 v249, v163, v163
    buffer_load_dwordx4 v6, s[24:27], s56 offen offset:1024 lds
    s_waitcnt lgkmcnt(6)
    v_dot2c_f32_bf16 v248, v164, v250
    v_dot2c_f32_bf16 v249, v164, v164
    v_dot2c_f32_bf16 v248, v165, v250
    v_dot2c_f32_bf16 v249, v165, v165
    v_dot2c_f32_bf16 v248, v166, v250
    v_dot2c_f32_bf16 v249, v166, v166
    v_dot2c_f32_bf16 v248, v167, v250
    v_dot2c_f32_bf16 v249, v167, v167
    buffer_load_dwordx4 v7, s[24:27], s56 offen offset:2048 lds
    s_waitcnt lgkmcnt(5)
    v_dot2c_f32_bf16 v248, v168, v250
    v_dot2c_f32_bf16 v249, v168, v168
    v_dot2c_f32_bf16 v248, v169, v250
    v_dot2c_f32_bf16 v249, v169, v169
    v_dot2c_f32_bf16 v248, v170, v250
    v_dot2c_f32_bf16 v249, v170, v170
    v_dot2c_f32_bf16 v248, v171, v250
    v_dot2c_f32_bf16 v249, v171, v171
    buffer_load_dwordx4 v8, s[24:27], s56 offen offset:3072 lds
    s_add_u32 m0, s64, 0x0
    s_mul_i32 s56, s70, 172032
    buffer_load_dwordx4 v13, s[28:31], s56 offen lds
    s_waitcnt lgkmcnt(4)
    v_dot2c_f32_bf16 v248, v172, v250
    v_dot2c_f32_bf16 v249, v172, v172
    v_dot2c_f32_bf16 v248, v173, v250
    v_dot2c_f32_bf16 v249, v173, v173
    v_dot2c_f32_bf16 v248, v174, v250
    v_dot2c_f32_bf16 v249, v174, v174
    v_dot2c_f32_bf16 v248, v175, v250
    v_dot2c_f32_bf16 v249, v175, v175
    s_waitcnt vmcnt(9)
    ds_read_b128 v[192:195], v9 offset:16384
    ds_read_b128 v[196:199], v10 offset:16384
    ds_read_b128 v[200:203], v11 offset:16384
    ds_read_b128 v[204:207], v12 offset:16384
    s_waitcnt lgkmcnt(7)
    v_dot2c_f32_bf16 v248, v176, v250
    v_dot2c_f32_bf16 v249, v176, v176
    v_dot2c_f32_bf16 v248, v177, v250
    v_dot2c_f32_bf16 v249, v177, v177
    v_dot2c_f32_bf16 v248, v178, v250
    v_dot2c_f32_bf16 v249, v178, v178
    v_dot2c_f32_bf16 v248, v179, v250
    v_dot2c_f32_bf16 v249, v179, v179
    s_waitcnt lgkmcnt(6)
    v_dot2c_f32_bf16 v248, v180, v250
    v_dot2c_f32_bf16 v249, v180, v180
    v_dot2c_f32_bf16 v248, v181, v250
    v_dot2c_f32_bf16 v249, v181, v181
    v_dot2c_f32_bf16 v248, v182, v250
    v_dot2c_f32_bf16 v249, v182, v182
    v_dot2c_f32_bf16 v248, v183, v250
    v_dot2c_f32_bf16 v249, v183, v183
    s_add_u32 m0, s64, 0x1000
    s_mul_i32 s56, s70, 172032
    s_add_u32 s56, s56, 86016
    buffer_load_dwordx4 v13, s[28:31], s56 offen lds
    s_waitcnt lgkmcnt(5)
    v_dot2c_f32_bf16 v248, v184, v250
    v_dot2c_f32_bf16 v249, v184, v184
    v_dot2c_f32_bf16 v248, v185, v250
    v_dot2c_f32_bf16 v249, v185, v185
    v_dot2c_f32_bf16 v248, v186, v250
    v_dot2c_f32_bf16 v249, v186, v186
    v_dot2c_f32_bf16 v248, v187, v250
    v_dot2c_f32_bf16 v249, v187, v187
    s_waitcnt lgkmcnt(4)
    v_dot2c_f32_bf16 v248, v188, v250
    v_dot2c_f32_bf16 v249, v188, v188
    v_dot2c_f32_bf16 v248, v189, v250
    v_dot2c_f32_bf16 v249, v189, v189
    v_dot2c_f32_bf16 v248, v190, v250
    v_dot2c_f32_bf16 v249, v190, v190
    v_dot2c_f32_bf16 v248, v191, v250
    v_dot2c_f32_bf16 v249, v191, v191
    s_waitcnt vmcnt(6)
    ds_read_b128 v[208:211], v9 offset:20480
    ds_read_b128 v[212:215], v10 offset:20480
    ds_read_b128 v[216:219], v11 offset:20480
    ds_read_b128 v[220:223], v12 offset:20480
    s_waitcnt lgkmcnt(7)
    v_dot2c_f32_bf16 v248, v192, v250
    v_dot2c_f32_bf16 v249, v192, v192
    v_dot2c_f32_bf16 v248, v193, v250
    v_dot2c_f32_bf16 v249, v193, v193
    v_dot2c_f32_bf16 v248, v194, v250
    v_dot2c_f32_bf16 v249, v194, v194
    v_dot2c_f32_bf16 v248, v195, v250
    v_dot2c_f32_bf16 v249, v195, v195
    s_add_u32 m0, s64, 0x2000
    s_mul_i32 s56, s71, 172032
    buffer_load_dwordx4 v13, s[28:31], s56 offen lds
    s_waitcnt lgkmcnt(6)
    v_dot2c_f32_bf16 v248, v196, v250
    v_dot2c_f32_bf16 v249, v196, v196
    v_dot2c_f32_bf16 v248, v197, v250
    v_dot2c_f32_bf16 v249, v197, v197
    v_dot2c_f32_bf16 v248, v198, v250
    v_dot2c_f32_bf16 v249, v198, v198
    v_dot2c_f32_bf16 v248, v199, v250
    v_dot2c_f32_bf16 v249, v199, v199
    s_waitcnt lgkmcnt(5)
    v_dot2c_f32_bf16 v248, v200, v250
    v_dot2c_f32_bf16 v249, v200, v200
    v_dot2c_f32_bf16 v248, v201, v250
    v_dot2c_f32_bf16 v249, v201, v201
    v_dot2c_f32_bf16 v248, v202, v250
    v_dot2c_f32_bf16 v249, v202, v202
    v_dot2c_f32_bf16 v248, v203, v250
    v_dot2c_f32_bf16 v249, v203, v203
    s_add_u32 m0, s64, 0x3000
    s_mul_i32 s56, s71, 172032
    s_add_u32 s56, s56, 86016
    buffer_load_dwordx4 v13, s[28:31], s56 offen lds
    s_waitcnt lgkmcnt(4)
    v_dot2c_f32_bf16 v248, v204, v250
    v_dot2c_f32_bf16 v249, v204, v204
    v_dot2c_f32_bf16 v248, v205, v250
    v_dot2c_f32_bf16 v249, v205, v205
    v_dot2c_f32_bf16 v248, v206, v250
    v_dot2c_f32_bf16 v249, v206, v206
    v_dot2c_f32_bf16 v248, v207, v250
    v_dot2c_f32_bf16 v249, v207, v207
    s_waitcnt vmcnt(4)
    ds_read_b128 v[224:227], v9 offset:24576
    ds_read_b128 v[228:231], v10 offset:24576
    ds_read_b128 v[232:235], v11 offset:24576
    ds_read_b128 v[236:239], v12 offset:24576
    s_waitcnt lgkmcnt(7)
    v_dot2c_f32_bf16 v248, v208, v250
    v_dot2c_f32_bf16 v249, v208, v208
    v_dot2c_f32_bf16 v248, v209, v250
    v_dot2c_f32_bf16 v249, v209, v209
    v_dot2c_f32_bf16 v248, v210, v250
    v_dot2c_f32_bf16 v249, v210, v210
    v_dot2c_f32_bf16 v248, v211, v250
    v_dot2c_f32_bf16 v249, v211, v211
    s_waitcnt lgkmcnt(6)
    v_dot2c_f32_bf16 v248, v212, v250
    v_dot2c_f32_bf16 v249, v212, v212
    v_dot2c_f32_bf16 v248, v213, v250
    v_dot2c_f32_bf16 v249, v213, v213
    v_dot2c_f32_bf16 v248, v214, v250
    v_dot2c_f32_bf16 v249, v214, v214
    v_dot2c_f32_bf16 v248, v215, v250
    v_dot2c_f32_bf16 v249, v215, v215
    s_add_u32 m0, s64, 0x4000
    s_mul_i32 s56, s72, 172032
    buffer_load_dwordx4 v13, s[28:31], s56 offen lds
    s_waitcnt lgkmcnt(5)
    v_dot2c_f32_bf16 v248, v216, v250
    v_dot2c_f32_bf16 v249, v216, v216
    v_dot2c_f32_bf16 v248, v217, v250
    v_dot2c_f32_bf16 v249, v217, v217
    v_dot2c_f32_bf16 v248, v218, v250
    v_dot2c_f32_bf16 v249, v218, v218
    v_dot2c_f32_bf16 v248, v219, v250
    v_dot2c_f32_bf16 v249, v219, v219
    s_waitcnt lgkmcnt(4)
    v_dot2c_f32_bf16 v248, v220, v250
    v_dot2c_f32_bf16 v249, v220, v220
    v_dot2c_f32_bf16 v248, v221, v250
    v_dot2c_f32_bf16 v249, v221, v221
    v_dot2c_f32_bf16 v248, v222, v250
    v_dot2c_f32_bf16 v249, v222, v222
    v_dot2c_f32_bf16 v248, v223, v250
    v_dot2c_f32_bf16 v249, v223, v223
    s_waitcnt lgkmcnt(3)
    v_dot2c_f32_bf16 v248, v224, v250
    v_dot2c_f32_bf16 v249, v224, v224
    v_dot2c_f32_bf16 v248, v225, v250
    v_dot2c_f32_bf16 v249, v225, v225
    v_dot2c_f32_bf16 v248, v226, v250
    v_dot2c_f32_bf16 v249, v226, v226
    v_dot2c_f32_bf16 v248, v227, v250
    v_dot2c_f32_bf16 v249, v227, v227
    s_waitcnt lgkmcnt(2)
    v_dot2c_f32_bf16 v248, v228, v250
    v_dot2c_f32_bf16 v249, v228, v228
    v_dot2c_f32_bf16 v248, v229, v250
    v_dot2c_f32_bf16 v249, v229, v229
    v_dot2c_f32_bf16 v248, v230, v250
    v_dot2c_f32_bf16 v249, v230, v230
    v_dot2c_f32_bf16 v248, v231, v250
    v_dot2c_f32_bf16 v249, v231, v231
    s_waitcnt lgkmcnt(1)
    v_dot2c_f32_bf16 v248, v232, v250
    v_dot2c_f32_bf16 v249, v232, v232
    v_dot2c_f32_bf16 v248, v233, v250
    v_dot2c_f32_bf16 v249, v233, v233
    v_dot2c_f32_bf16 v248, v234, v250
    v_dot2c_f32_bf16 v249, v234, v234
    v_dot2c_f32_bf16 v248, v235, v250
    v_dot2c_f32_bf16 v249, v235, v235
    s_waitcnt lgkmcnt(0)
    v_dot2c_f32_bf16 v248, v236, v250
    v_dot2c_f32_bf16 v249, v236, v236
    v_dot2c_f32_bf16 v248, v237, v250
    v_dot2c_f32_bf16 v249, v237, v237
    v_dot2c_f32_bf16 v248, v238, v250
    v_dot2c_f32_bf16 v249, v238, v238
    v_dot2c_f32_bf16 v248, v239, v250
    v_dot2c_f32_bf16 v249, v239, v239
    s_add_u32 m0, s64, 0x5000
    s_mul_i32 s56, s72, 172032
    s_add_u32 s56, s56, 86016
    buffer_load_dwordx4 v13, s[28:31], s56 offen lds
    s_lshl_b32 s3, s62, 11
    v_add_u32 v34, s3, v14
    v_add_u32 v35, s3, v15
    v_add_u32 v44, s64, v17
    v_mov_b32 v40, 0x3f803f80
    v_mov_b32 v41, 0x3f803f80
    v_mov_b32 v42, 0x3f803f80
    v_mov_b32 v43, 0x3f803f80
    s_add_u32 m0, s64, 0x6000
    s_mul_i32 s56, s73, 172032
    buffer_load_dwordx4 v13, s[28:31], s56 offen lds
    s_waitcnt vmcnt(5)
    s_barrier
    ds_read_b64_tr_b16 a[0:1], v14 offset:0
    ds_read_b64_tr_b16 a[2:3], v14 offset:512
    ds_read_b64_tr_b16 a[4:5], v15 offset:0
    ds_read_b64_tr_b16 a[6:7], v15 offset:512
    ds_read_b64_tr_b16 a[8:9], v14 offset:2048
    ds_read_b64_tr_b16 a[10:11], v14 offset:2560
    ds_read_b64_tr_b16 a[12:13], v15 offset:2048
    ds_read_b64_tr_b16 a[14:15], v15 offset:2560
    s_waitcnt lgkmcnt(4)
    v_mfma_f32_32x32x16_bf16 v[64:79], v[128:131], a[0:3], 0
    ds_read_b64_tr_b16 a[16:17], v34 offset:0
    ds_read_b64_tr_b16 a[18:19], v34 offset:512
    v_mfma_f32_32x32x16_bf16 v[80:95], v[128:131], a[4:7], 0
    ds_read_b64_tr_b16 a[20:21], v35 offset:0
    ds_read_b64_tr_b16 a[22:23], v35 offset:512
    s_waitcnt lgkmcnt(4)
    v_mfma_f32_32x32x16_bf16 v[64:79], v[132:135], a[8:11], v[64:79]
    s_add_u32 m0, s64, 0x7000
    ds_read_b64_tr_b16 a[24:25], v14 offset:4096
    ds_read_b64_tr_b16 a[26:27], v14 offset:4608
    s_mul_i32 s56, s73, 172032
    s_add_u32 s56, s56, 86016
    buffer_load_dwordx4 v13, s[28:31], s56 offen lds
    v_mov_b32 v26, v248
    v_mfma_f32_32x32x16_bf16 v[80:95], v[132:135], a[12:15], v[80:95]
    ds_read_b64_tr_b16 a[28:29], v15 offset:4096
    ds_read_b64_tr_b16 a[30:31], v15 offset:4608
    v_permlane32_swap_b32 v26, v248
    s_waitcnt lgkmcnt(4)
    v_mfma_f32_32x32x16_bf16 a[40:55], v[40:43], a[16:19], 0
    ds_read_b64_tr_b16 a[0:1], v14 offset:6144
    ds_read_b64_tr_b16 a[2:3], v14 offset:6656
    v_add_f32 v248, v26, v248
    v_mfma_f32_32x32x16_bf16 a[56:71], v[40:43], a[20:23], 0
    ds_read_b64_tr_b16 a[4:5], v15 offset:6144
    ds_read_b64_tr_b16 a[6:7], v15 offset:6656
    v_mov_b32 v26, v249
    s_waitcnt lgkmcnt(4)
    v_mfma_f32_32x32x16_bf16 v[64:79], v[136:139], a[24:27], v[64:79]
    s_waitcnt vmcnt(4)
    s_barrier
    ds_read_b64_tr_b16 a[8:9], v14 offset:8192
    ds_read_b64_tr_b16 a[10:11], v14 offset:8704
    v_permlane32_swap_b32 v26, v249
    v_mfma_f32_32x32x16_bf16 v[80:95], v[136:139], a[28:31], v[80:95]
    ds_read_b64_tr_b16 a[12:13], v15 offset:8192
    ds_read_b64_tr_b16 a[14:15], v15 offset:8704
    v_add_f32 v249, v26, v249
    s_waitcnt lgkmcnt(4)
    v_mfma_f32_32x32x16_bf16 v[64:79], v[140:143], a[0:3], v[64:79]
    s_add_u32 m0, s64, 0x8000
    ds_read_b64_tr_b16 a[16:17], v14 offset:10240
    ds_read_b64_tr_b16 a[18:19], v14 offset:10752
    s_mul_i32 s56, s74, 172032
    buffer_load_dwordx4 v13, s[28:31], s56 offen lds
    v_mul_f32 v246, 0x3b124925, v248
    v_mfma_f32_32x32x16_bf16 v[80:95], v[140:143], a[4:7], v[80:95]
    ds_read_b64_tr_b16 a[20:21], v15 offset:10240
    ds_read_b64_tr_b16 a[22:23], v15 offset:10752
    v_mul_f32 v247, 0x3b124925, v249
    s_waitcnt lgkmcnt(4)
    v_mfma_f32_32x32x16_bf16 v[64:79], v[144:147], a[8:11], v[64:79]
    ds_read_b64_tr_b16 a[24:25], v34 offset:8192
    ds_read_b64_tr_b16 a[26:27], v34 offset:8704
    v_fma_f32 v247, -v246, v246, v247
    v_mfma_f32_32x32x16_bf16 v[80:95], v[144:147], a[12:15], v[80:95]
    ds_read_b64_tr_b16 a[28:29], v35 offset:8192
    ds_read_b64_tr_b16 a[30:31], v35 offset:8704
    v_max_f32 v247, 0, v247
    s_waitcnt lgkmcnt(4)
    v_mfma_f32_32x32x16_bf16 v[64:79], v[148:151], a[16:19], v[64:79]
    ds_read_b64_tr_b16 a[0:1], v14 offset:12288
    ds_read_b64_tr_b16 a[2:3], v14 offset:12800
    v_cvt_pk_bf16_f32 v246, v246, v247
    v_mfma_f32_32x32x16_bf16 v[80:95], v[148:151], a[20:23], v[80:95]
    ds_read_b64_tr_b16 a[4:5], v15 offset:12288
    ds_read_b64_tr_b16 a[6:7], v15 offset:12800
    v_and_b32 v247, 0xffff0000, v246
    s_waitcnt lgkmcnt(4)
    v_mfma_f32_32x32x16_bf16 a[40:55], v[40:43], a[24:27], a[40:55]
    s_add_u32 m0, s64, 0x9000
    ds_read_b64_tr_b16 a[8:9], v14 offset:14336
    ds_read_b64_tr_b16 a[10:11], v14 offset:14848
    s_mul_i32 s56, s74, 172032
    s_add_u32 s56, s56, 86016
    buffer_load_dwordx4 v13, s[28:31], s56 offen lds
    v_lshlrev_b32 v246, 16, v246
    v_mfma_f32_32x32x16_bf16 a[56:71], v[40:43], a[28:31], a[56:71]
    ds_read_b64_tr_b16 a[12:13], v15 offset:14336
    ds_read_b64_tr_b16 a[14:15], v15 offset:14848
    v_add_f32 v247, 0x3727c5ac, v247
    s_waitcnt lgkmcnt(4)
    v_mfma_f32_32x32x16_bf16 v[64:79], v[152:155], a[0:3], v[64:79]
    s_waitcnt vmcnt(4)
    s_barrier
    ds_read_b64_tr_b16 a[16:17], v14 offset:16384
    ds_read_b64_tr_b16 a[18:19], v14 offset:16896
    v_cvt_pk_bf16_f32 v247, v247, v247
    v_mfma_f32_32x32x16_bf16 v[80:95], v[152:155], a[4:7], v[80:95]
    ds_read_b64_tr_b16 a[20:21], v15 offset:16384
    ds_read_b64_tr_b16 a[22:23], v15 offset:16896
    v_lshlrev_b32 v247, 16, v247
    s_waitcnt lgkmcnt(4)
    v_mfma_f32_32x32x16_bf16 v[64:79], v[156:159], a[8:11], v[64:79]
    ds_read_b64_tr_b16 a[24:25], v14 offset:18432
    ds_read_b64_tr_b16 a[26:27], v14 offset:18944
    v_sqrt_f32 v247, v247
    v_mfma_f32_32x32x16_bf16 v[80:95], v[156:159], a[12:15], v[80:95]
    ds_read_b64_tr_b16 a[28:29], v15 offset:18432
    ds_read_b64_tr_b16 a[30:31], v15 offset:18944
    v_cvt_pk_bf16_f32 v247, v247, v247
    s_waitcnt lgkmcnt(4)
    v_mfma_f32_32x32x16_bf16 v[64:79], v[160:163], a[16:19], v[64:79]
    s_add_u32 m0, s64, 0xa000
    ds_read_b64_tr_b16 a[0:1], v34 offset:16384
    ds_read_b64_tr_b16 a[2:3], v34 offset:16896
    s_mul_i32 s56, s75, 172032
    buffer_load_dwordx4 v13, s[28:31], s56 offen lds
    v_lshlrev_b32 v247, 16, v247
    v_mfma_f32_32x32x16_bf16 v[80:95], v[160:163], a[20:23], v[80:95]
    ds_read_b64_tr_b16 a[4:5], v35 offset:16384
    ds_read_b64_tr_b16 a[6:7], v35 offset:16896
    v_rcp_f32 v252, v247
    s_waitcnt lgkmcnt(4)
    v_mfma_f32_32x32x16_bf16 v[64:79], v[164:167], a[24:27], v[64:79]
    ds_read_b64_tr_b16 a[8:9], v14 offset:20480
    ds_read_b64_tr_b16 a[10:11], v14 offset:20992
    v_mul_f32 v26, v246, v252
    v_mfma_f32_32x32x16_bf16 v[80:95], v[164:167], a[28:31], v[80:95]
    ds_read_b64_tr_b16 a[12:13], v15 offset:20480
    ds_read_b64_tr_b16 a[14:15], v15 offset:20992
    v_mul_f32 v254, 0x3fb8aa3b, v252
    s_waitcnt lgkmcnt(4)
    v_mfma_f32_32x32x16_bf16 a[40:55], v[40:43], a[0:3], a[40:55]
    ds_read_b64_tr_b16 a[16:17], v14 offset:22528
    ds_read_b64_tr_b16 a[18:19], v14 offset:23040
    v_sub_f32 v26, 0, v26
    v_mfma_f32_32x32x16_bf16 a[56:71], v[40:43], a[4:7], a[56:71]
    ds_read_b64_tr_b16 a[20:21], v15 offset:22528
    ds_read_b64_tr_b16 a[22:23], v15 offset:23040
    s_waitcnt lgkmcnt(4)
    v_mfma_f32_32x32x16_bf16 v[64:79], v[168:171], a[8:11], v[64:79]
    s_add_u32 m0, s64, 0xb000
    s_waitcnt vmcnt(3)
    s_barrier
    ds_read_b64_tr_b16 a[24:25], v14 offset:24576
    ds_read_b64_tr_b16 a[26:27], v14 offset:25088
    s_mul_i32 s56, s75, 172032
    s_add_u32 s56, s56, 86016
    buffer_load_dwordx4 v13, s[28:31], s56 offen lds
    v_mfma_f32_32x32x16_bf16 v[80:95], v[168:171], a[12:15], v[80:95]
    ds_read_b64_tr_b16 a[28:29], v15 offset:24576
    ds_read_b64_tr_b16 a[30:31], v15 offset:25088
    s_waitcnt lgkmcnt(4)
    v_mfma_f32_32x32x16_bf16 v[64:79], v[172:175], a[16:19], v[64:79]
    ds_read_b64_tr_b16 a[0:1], v14 offset:26624
    ds_read_b64_tr_b16 a[2:3], v14 offset:27136
    ds_write_b32 v29, v252
    ds_write_b32 v29, v26 offset:128
    v_mfma_f32_32x32x16_bf16 v[80:95], v[172:175], a[20:23], v[80:95]
    ds_read_b64_tr_b16 a[4:5], v15 offset:26624
    ds_read_b64_tr_b16 a[6:7], v15 offset:27136
    s_waitcnt lgkmcnt(6)
    v_mfma_f32_32x32x16_bf16 v[64:79], v[176:179], a[24:27], v[64:79]
    ds_read_b64_tr_b16 a[8:9], v34 offset:24576
    ds_read_b64_tr_b16 a[10:11], v34 offset:25088
    ds_read_b128 v[96:99], v30 offset:0
    v_cvt_pk_bf16_f32 v36, -v246, -v246
    v_mfma_f32_32x32x16_bf16 v[80:95], v[176:179], a[28:31], v[80:95]
    ds_read_b64_tr_b16 a[12:13], v35 offset:24576
    ds_read_b64_tr_b16 a[14:15], v35 offset:25088
    ds_read_b128 v[100:103], v30 offset:32
    v_mov_b32 v37, 0
    s_waitcnt lgkmcnt(8)
    v_mfma_f32_32x32x16_bf16 v[64:79], v[180:183], a[0:3], v[64:79]
    s_add_u32 m0, s64, 0xc000
    ds_read_b64_tr_b16 a[16:17], v14 offset:28672
    ds_read_b64_tr_b16 a[18:19], v14 offset:29184
    s_mul_i32 s56, s76, 172032
    buffer_load_dwordx4 v13, s[28:31], s56 offen lds
    ds_read_b128 v[104:107], v30 offset:64
    v_mov_b32 v38, 0
    s_waitcnt lgkmcnt(9)
    v_mfma_f32_32x32x16_bf16 v[80:95], v[180:183], a[4:7], v[80:95]
    ds_read_b64_tr_b16 a[20:21], v15 offset:28672
    ds_read_b64_tr_b16 a[22:23], v15 offset:29184
    ds_read_b128 v[108:111], v30 offset:96
    v_mov_b32 v39, 0
    s_waitcnt lgkmcnt(8)
    v_mfma_f32_32x32x16_bf16 a[40:55], v[40:43], a[8:11], a[40:55]
    ds_read_b64_tr_b16 a[24:25], v14 offset:30720
    ds_read_b64_tr_b16 a[26:27], v14 offset:31232
    ds_read_b128 v[112:115], v30 offset:128
    v_cndmask_b32 v36, v36, 0, s[14:15]
    s_waitcnt lgkmcnt(10)
    v_mfma_f32_32x32x16_bf16 a[56:71], v[40:43], a[12:15], a[56:71]
    ds_read_b64_tr_b16 a[28:29], v15 offset:30720
    ds_read_b64_tr_b16 a[30:31], v15 offset:31232
    ds_read_b128 v[116:119], v30 offset:160
    v_lshlrev_b32 v26, 3, v243
    s_waitcnt lgkmcnt(8)
    v_mfma_f32_32x32x16_bf16 v[64:79], v[184:187], a[16:19], v[64:79]
    s_waitcnt vmcnt(3)
    s_barrier
    ds_read_b64_tr_b16 a[0:1], v14 offset:32768
    ds_read_b64_tr_b16 a[2:3], v14 offset:33280
    ds_read_b128 v[120:123], v30 offset:192
    v_add_u32 v31, 105472, v26
    s_waitcnt lgkmcnt(10)
    v_mfma_f32_32x32x16_bf16 v[80:95], v[184:187], a[20:23], v[80:95]
    ds_read_b64_tr_b16 a[4:5], v15 offset:32768
    ds_read_b64_tr_b16 a[6:7], v15 offset:33280
    ds_read_b128 v[124:127], v30 offset:224
    v_mov_b32 v244, 0x3fb8aa3b
    s_waitcnt lgkmcnt(8)
    v_mfma_f32_32x32x16_bf16 v[64:79], v[188:191], a[24:27], v[64:79]
    s_add_u32 m0, s64, 0xd000
    ds_read_b64_tr_b16 a[8:9], v14 offset:34816
    ds_read_b64_tr_b16 a[10:11], v14 offset:35328
    s_mul_i32 s56, s76, 172032
    s_add_u32 s56, s56, 86016
    buffer_load_dwordx4 v13, s[28:31], s56 offen lds
    v_mov_b32 v245, v243
    s_waitcnt lgkmcnt(9)
    v_mfma_f32_32x32x16_bf16 v[80:95], v[188:191], a[28:31], v[80:95]
    ds_read_b64_tr_b16 a[12:13], v15 offset:34816
    ds_read_b64_tr_b16 a[14:15], v15 offset:35328
    s_waitcnt lgkmcnt(6)
    v_mfma_f32_32x32x16_bf16 v[64:79], v[192:195], a[0:3], v[64:79]
    ds_read_b64_tr_b16 a[16:17], v34 offset:32768
    ds_read_b64_tr_b16 a[18:19], v34 offset:33280
    s_lshl_b32 s3, s62, 8
    v_add_u32 v30, s3, v31
    s_lshl4_add_u32 s3, s61, s60
    s_lshl2_add_u32 s3, s3, s62
    s_lshl_b32 s3, s3, 9
    s_add_u32 s57, s3, 131072
    s_mov_b32 s8, s36
    s_mov_b32 s9, s37
    s_mul_i32 s10, s19, 1605632
    s_mov_b32 s11, 0x20000
    buffer_load_dword a250, v32, s[8:11], 0 offen
    s_mov_b32 s8, s32
    s_mov_b32 s9, s33
    s_mul_i32 s10, s19, 401408
    buffer_load_dword a251, v33, s[8:11], 0 offen
    s_waitcnt lgkmcnt(7)
    v_mfma_f32_32x32x16_bf16 v[80:95], v[192:195], a[4:7], v[80:95]
    ds_read_b64_tr_b16 a[20:21], v35 offset:32768
    ds_read_b64_tr_b16 a[22:23], v35 offset:33280
    s_waitcnt lgkmcnt(4)
    v_mfma_f32_32x32x16_bf16 v[64:79], v[196:199], a[8:11], v[64:79]
    ds_read_b64_tr_b16 a[24:25], v14 offset:36864
    ds_read_b64_tr_b16 a[26:27], v14 offset:37376
    v_mfma_f32_32x32x16_bf16 v[80:95], v[196:199], a[12:15], v[80:95]
    ds_read_b64_tr_b16 a[28:29], v15 offset:36864
    ds_read_b64_tr_b16 a[30:31], v15 offset:37376
    s_waitcnt lgkmcnt(4)
    v_mfma_f32_32x32x16_bf16 a[40:55], v[40:43], a[16:19], a[40:55]
    ds_read_b64_tr_b16 a[0:1], v14 offset:38912
    ds_read_b64_tr_b16 a[2:3], v14 offset:39424
    s_lshl_b32 s3, s61, 6
    s_add_u32 s3, s3, s62
    s_lshl_b32 s3, s3, 7
    s_add_u32 s59, s3, 1536
    s_add_u32 m0, s64, 0xe000
    s_mul_i32 s56, s70, 172032
    buffer_load_dwordx4 v16, s[28:31], s56 offen lds
    v_mfma_f32_32x32x16_bf16 a[56:71], v[40:43], a[20:23], a[56:71]
    ds_read_b64_tr_b16 a[4:5], v15 offset:38912
    ds_read_b64_tr_b16 a[6:7], v15 offset:39424
    s_waitcnt lgkmcnt(4)
    v_mfma_f32_32x32x16_bf16 v[64:79], v[200:203], a[24:27], v[64:79]
    s_waitcnt vmcnt(5)
    s_barrier
    ds_read_b64_tr_b16 a[8:9], v14 offset:40960
    ds_read_b64_tr_b16 a[10:11], v14 offset:41472
    v_mfma_f32_32x32x16_bf16 v[80:95], v[200:203], a[28:31], v[80:95]
    ds_read_b64_tr_b16 a[12:13], v15 offset:40960
    ds_read_b64_tr_b16 a[14:15], v15 offset:41472
    s_waitcnt lgkmcnt(4)
    v_mfma_f32_32x32x16_bf16 v[64:79], v[204:207], a[0:3], v[64:79]
    ds_read_b64_tr_b16 a[16:17], v14 offset:43008
    ds_read_b64_tr_b16 a[18:19], v14 offset:43520
    s_lshl_b32 s3, s62, 12
    s_add_u32 s3, s3, 86016
    v_add_u32 v46, s3, v1
    s_add_u32 s3, s64, 86016
    v_add_u32 v47, s3, v1
    v_mfma_f32_32x32x16_bf16 v[80:95], v[204:207], a[4:7], v[80:95]
    s_add_u32 m0, s64, 0xf000
    ds_read_b64_tr_b16 a[20:21], v15 offset:43008
    ds_read_b64_tr_b16 a[22:23], v15 offset:43520
    s_mul_i32 s56, s71, 172032
    buffer_load_dwordx4 v16, s[28:31], s56 offen lds
    s_waitcnt lgkmcnt(4)
    v_mfma_f32_32x32x16_bf16 v[64:79], v[208:211], a[8:11], v[64:79]
    ds_read_b64_tr_b16 a[24:25], v34 offset:40960
    ds_read_b64_tr_b16 a[26:27], v34 offset:41472
    v_mfma_f32_32x32x16_bf16 v[80:95], v[208:211], a[12:15], v[80:95]
    ds_read_b64_tr_b16 a[28:29], v35 offset:40960
    ds_read_b64_tr_b16 a[30:31], v35 offset:41472
    s_waitcnt lgkmcnt(4)
    v_mfma_f32_32x32x16_bf16 v[64:79], v[212:215], a[16:19], v[64:79]
    ds_read_b64_tr_b16 a[0:1], v14 offset:45056
    ds_read_b64_tr_b16 a[2:3], v14 offset:45568
    v_mfma_f32_32x32x16_bf16 v[80:95], v[212:215], a[20:23], v[80:95]
    ds_read_b64_tr_b16 a[4:5], v15 offset:45056
    ds_read_b64_tr_b16 a[6:7], v15 offset:45568
    s_waitcnt lgkmcnt(4)
    v_mfma_f32_32x32x16_bf16 a[40:55], v[40:43], a[24:27], a[40:55]
    s_add_u32 m0, s64, 0x10000
    ds_read_b64_tr_b16 a[8:9], v14 offset:47104
    ds_read_b64_tr_b16 a[10:11], v14 offset:47616
    s_mul_i32 s56, s72, 172032
    buffer_load_dwordx4 v16, s[28:31], s56 offen lds
    v_mfma_f32_32x32x16_bf16 a[56:71], v[40:43], a[28:31], a[56:71]
    ds_read_b64_tr_b16 a[12:13], v15 offset:47104
    ds_read_b64_tr_b16 a[14:15], v15 offset:47616
    s_waitcnt lgkmcnt(4)
    v_mfma_f32_32x32x16_bf16 v[64:79], v[216:219], a[0:3], v[64:79]
    s_waitcnt vmcnt(6)
    s_barrier
    ds_read_b64_tr_b16 a[16:17], v14 offset:49152
    ds_read_b64_tr_b16 a[18:19], v14 offset:49664
    v_mfma_f32_32x32x16_bf16 v[80:95], v[216:219], a[4:7], v[80:95]
    ds_read_b64_tr_b16 a[20:21], v15 offset:49152
    ds_read_b64_tr_b16 a[22:23], v15 offset:49664
    s_waitcnt lgkmcnt(4)
    v_mfma_f32_32x32x16_bf16 v[64:79], v[220:223], a[8:11], v[64:79]
    ds_read_b64_tr_b16 a[24:25], v14 offset:51200
    ds_read_b64_tr_b16 a[26:27], v14 offset:51712
    v_mfma_f32_32x32x16_bf16 v[80:95], v[220:223], a[12:15], v[80:95]
    s_add_u32 m0, s64, 0x11000
    ds_read_b64_tr_b16 a[28:29], v15 offset:51200
    ds_read_b64_tr_b16 a[30:31], v15 offset:51712
    s_mul_i32 s56, s73, 172032
    buffer_load_dwordx4 v16, s[28:31], s56 offen lds
    s_waitcnt lgkmcnt(4)
    v_mfma_f32_32x32x16_bf16 v[64:79], v[224:227], a[16:19], v[64:79]
    s_waitcnt vmcnt(6)
    s_barrier
    ds_read_b64_tr_b16 a[0:1], v34 offset:49152
    ds_read_b64_tr_b16 a[2:3], v34 offset:49664
    v_mfma_f32_32x32x16_bf16 v[80:95], v[224:227], a[20:23], v[80:95]
    ds_read_b64_tr_b16 a[4:5], v35 offset:49152
    ds_read_b64_tr_b16 a[6:7], v35 offset:49664
    s_waitcnt lgkmcnt(4)
    v_mfma_f32_32x32x16_bf16 v[64:79], v[228:231], a[24:27], v[64:79]
    ds_read_b64_tr_b16 a[8:9], v14 offset:53248
    ds_read_b64_tr_b16 a[10:11], v14 offset:53760
    v_mfma_f32_32x32x16_bf16 v[80:95], v[228:231], a[28:31], v[80:95]
    ds_read_b64_tr_b16 a[12:13], v15 offset:53248
    ds_read_b64_tr_b16 a[14:15], v15 offset:53760
    s_waitcnt lgkmcnt(4)
    v_mfma_f32_32x32x16_bf16 a[40:55], v[40:43], a[0:3], a[40:55]
    s_add_u32 m0, s64, 0x12000
    ds_read_b64_tr_b16 a[16:17], v14 offset:55296
    ds_read_b64_tr_b16 a[18:19], v14 offset:55808
    s_mul_i32 s56, s74, 172032
    buffer_load_dwordx4 v16, s[28:31], s56 offen lds
    v_mfma_f32_32x32x16_bf16 a[56:71], v[40:43], a[4:7], a[56:71]
    ds_read_b64_tr_b16 a[20:21], v15 offset:55296
    ds_read_b64_tr_b16 a[22:23], v15 offset:55808
    s_waitcnt lgkmcnt(4)
    v_mfma_f32_32x32x16_bf16 v[64:79], v[232:235], a[8:11], v[64:79]
    v_mfma_f32_32x32x16_bf16 v[80:95], v[232:235], a[12:15], v[80:95]
    s_nop 0
    v_accvgpr_read_b32 v26, a40
    s_nop 4
    v_accvgpr_read_b32 v27, a56
    ds_write_b64 v30, v[26:27]
    s_waitcnt lgkmcnt(1)
    v_mfma_f32_32x32x16_bf16 v[64:79], v[236:239], a[16:19], v[64:79]
    s_waitcnt lgkmcnt(0)
    s_barrier
    ds_read_b64 v[48:49], v31 offset:0
    ds_read_b64 v[50:51], v31 offset:256
    ds_read_b64 v[52:53], v31 offset:512
    ds_read_b64 v[54:55], v31 offset:768
    v_mfma_f32_32x32x16_bf16 v[80:95], v[236:239], a[20:23], v[80:95]
    s_waitcnt lgkmcnt(2)
    v_pk_add_f32 v[48:49], v[48:49], v[50:51]
    s_waitcnt lgkmcnt(0)
    v_pk_add_f32 v[52:53], v[52:53], v[54:55]
    v_pk_add_f32 v[26:27], v[48:49], v[52:53]
    v_mov_b32 v28, v27
    v_pk_mul_f32 v[240:241], v[112:113], v[28:29] op_sel_hi:[1,0]
    v_pk_mul_f32 v[242:243], v[114:115], v[28:29] op_sel_hi:[1,0]
    s_nop 3
    v_pk_fma_f32 v[80:81], v[80:81], v[96:97], v[240:241]
    v_pk_fma_f32 v[82:83], v[82:83], v[98:99], v[242:243]
    v_cvt_pk_bf16_f32 v56, v80, v81
    v_cvt_pk_bf16_f32 v57, v82, v83
    v_cndmask_b32 v56, v56, v250, s[16:17]
    v_cndmask_b32 v57, v57, v250, s[16:17]
    v_pk_mul_f32 v[240:241], v[116:117], v[28:29] op_sel_hi:[1,0]
    v_pk_mul_f32 v[242:243], v[118:119], v[28:29] op_sel_hi:[1,0]
    v_pk_fma_f32 v[84:85], v[84:85], v[100:101], v[240:241]
    v_pk_fma_f32 v[86:87], v[86:87], v[102:103], v[242:243]
    v_cvt_pk_bf16_f32 v58, v84, v85
    v_cvt_pk_bf16_f32 v59, v86, v87
    v_cndmask_b32 v58, v58, v250, s[16:17]
    v_cndmask_b32 v59, v59, v250, s[16:17]
    v_pk_mul_f32 v[240:241], v[120:121], v[28:29] op_sel_hi:[1,0]
    v_pk_mul_f32 v[242:243], v[122:123], v[28:29] op_sel_hi:[1,0]
    v_pk_fma_f32 v[88:89], v[88:89], v[104:105], v[240:241]
    v_pk_fma_f32 v[90:91], v[90:91], v[106:107], v[242:243]
    v_cvt_pk_bf16_f32 v60, v88, v89
    v_cvt_pk_bf16_f32 v61, v90, v91
    v_cndmask_b32 v60, v60, v250, s[16:17]
    v_cndmask_b32 v61, v61, v250, s[16:17]
    v_pk_mul_f32 v[240:241], v[124:125], v[28:29] op_sel_hi:[1,0]
    v_pk_mul_f32 v[242:243], v[126:127], v[28:29] op_sel_hi:[1,0]
    v_pk_fma_f32 v[92:93], v[92:93], v[108:109], v[240:241]
    v_pk_fma_f32 v[94:95], v[94:95], v[110:111], v[242:243]
    v_cvt_pk_bf16_f32 v62, v92, v93
    v_cvt_pk_bf16_f32 v63, v94, v95
    v_cndmask_b32 v62, v62, v250, s[16:17]
    v_cndmask_b32 v63, v63, v250, s[16:17]
    v_pk_mul_f32 v[240:241], v[112:113], v[26:27] op_sel_hi:[1,0]
    v_pk_mul_f32 v[242:243], v[114:115], v[26:27] op_sel_hi:[1,0]
    v_pk_fma_f32 v[64:65], v[64:65], v[96:97], v[240:241]
    v_pk_fma_f32 v[66:67], v[66:67], v[98:99], v[242:243]
    v_pk_mul_f32 v[240:241], v[64:65], v[244:245] op_sel_hi:[1,0]
    v_pk_mul_f32 v[242:243], v[66:67], v[244:245] op_sel_hi:[1,0]
    v_exp_f32 v240, v240 clamp
    v_exp_f32 v242, v242 clamp
    v_exp_f32 v241, v241 clamp
    v_exp_f32 v243, v243 clamp
    v_max_f32 v64, 0x358637bd, v64
    v_max_f32 v66, 0x358637bd, v66
    v_max_f32 v65, 0x358637bd, v65
    v_max_f32 v67, 0x358637bd, v67
    v_pk_add_f32 v[64:65], v[64:65], v[240:241]
    v_pk_add_f32 v[66:67], v[66:67], v[242:243]
    v_cvt_pk_bf16_f32 v48, v64, v65
    v_cvt_pk_bf16_f32 v49, v66, v67
    v_pk_mul_f32 v[240:241], v[116:117], v[26:27] op_sel_hi:[1,0]
    v_pk_mul_f32 v[242:243], v[118:119], v[26:27] op_sel_hi:[1,0]
    v_pk_fma_f32 v[68:69], v[68:69], v[100:101], v[240:241]
    v_pk_fma_f32 v[70:71], v[70:71], v[102:103], v[242:243]
    v_pk_mul_f32 v[240:241], v[68:69], v[244:245] op_sel_hi:[1,0]
    v_pk_mul_f32 v[242:243], v[70:71], v[244:245] op_sel_hi:[1,0]
    v_exp_f32 v240, v240 clamp
    v_exp_f32 v242, v242 clamp
    v_exp_f32 v241, v241 clamp
    v_exp_f32 v243, v243 clamp
    v_max_f32 v68, 0x358637bd, v68
    v_max_f32 v70, 0x358637bd, v70
    v_max_f32 v69, 0x358637bd, v69
    v_max_f32 v71, 0x358637bd, v71
    v_pk_add_f32 v[68:69], v[68:69], v[240:241]
    v_pk_add_f32 v[70:71], v[70:71], v[242:243]
    v_cvt_pk_bf16_f32 v50, v68, v69
    v_cvt_pk_bf16_f32 v51, v70, v71
    v_pk_mul_f32 v[240:241], v[120:121], v[26:27] op_sel_hi:[1,0]
    v_pk_mul_f32 v[242:243], v[122:123], v[26:27] op_sel_hi:[1,0]
    v_pk_fma_f32 v[72:73], v[72:73], v[104:105], v[240:241]
    v_pk_fma_f32 v[74:75], v[74:75], v[106:107], v[242:243]
    v_pk_mul_f32 v[240:241], v[72:73], v[244:245] op_sel_hi:[1,0]
    v_pk_mul_f32 v[242:243], v[74:75], v[244:245] op_sel_hi:[1,0]
    v_exp_f32 v240, v240 clamp
    v_exp_f32 v242, v242 clamp
    v_exp_f32 v241, v241 clamp
    v_exp_f32 v243, v243 clamp
    v_max_f32 v72, 0x358637bd, v72
    v_max_f32 v74, 0x358637bd, v74
    v_max_f32 v73, 0x358637bd, v73
    v_max_f32 v75, 0x358637bd, v75
    v_pk_add_f32 v[72:73], v[72:73], v[240:241]
    v_pk_add_f32 v[74:75], v[74:75], v[242:243]
    v_cvt_pk_bf16_f32 v52, v72, v73
    v_cvt_pk_bf16_f32 v53, v74, v75
    v_pk_mul_f32 v[240:241], v[124:125], v[26:27] op_sel_hi:[1,0]
    v_pk_mul_f32 v[242:243], v[126:127], v[26:27] op_sel_hi:[1,0]
    v_pk_fma_f32 v[76:77], v[76:77], v[108:109], v[240:241]
    v_pk_fma_f32 v[78:79], v[78:79], v[110:111], v[242:243]
    v_pk_mul_f32 v[240:241], v[76:77], v[244:245] op_sel_hi:[1,0]
    v_pk_mul_f32 v[242:243], v[78:79], v[244:245] op_sel_hi:[1,0]
    v_exp_f32 v240, v240 clamp
    v_exp_f32 v242, v242 clamp
    v_exp_f32 v241, v241 clamp
    v_exp_f32 v243, v243 clamp
    v_max_f32 v76, 0x358637bd, v76
    v_max_f32 v78, 0x358637bd, v78
    v_max_f32 v77, 0x358637bd, v77
    v_max_f32 v79, 0x358637bd, v79
    v_pk_add_f32 v[76:77], v[76:77], v[240:241]
    v_pk_add_f32 v[78:79], v[78:79], v[242:243]
    v_cvt_pk_bf16_f32 v54, v76, v77
    v_cvt_pk_bf16_f32 v55, v78, v79
    v_mfma_f32_32x32x16_bf16 v[96:111], v[48:51], v[56:59], 0
    s_nop 0
    v_mfma_f32_32x32x16_bf16 v[96:111], v[52:55], v[60:63], v[96:111]
    buffer_load_dword v3, off, s[52:55], 0 sc1
    v_lshlrev_b32 v31, 2, v245
    v_add_u32 v31, 104448, v31
    s_lshl_b32 s3, s62, 7
    v_add_u32 v30, s3, v31
    s_nop 6
    ds_write_b128 v46, v[96:99] offset:0
    ds_write_b128 v46, v[100:103] offset:1024
    ds_write_b128 v46, v[104:107] offset:2048
    ds_write_b128 v46, v[108:111] offset:3072
    s_waitcnt lgkmcnt(0)
    s_barrier
    ds_read_b128 v[64:67], v47 offset:0
    ds_read_b128 v[68:71], v47 offset:4096
    ds_read_b128 v[72:75], v47 offset:8192
    ds_read_b128 v[76:79], v47 offset:12288
    s_waitcnt lgkmcnt(2)
    v_pk_add_f32 v[64:65], v[64:65], v[68:69]
    v_pk_add_f32 v[66:67], v[66:67], v[70:71]
    s_waitcnt lgkmcnt(0)
    v_pk_add_f32 v[72:73], v[72:73], v[76:77]
    v_pk_add_f32 v[74:75], v[74:75], v[78:79]
    v_pk_add_f32 v[64:65], v[64:65], v[72:73]
    v_pk_add_f32 v[66:67], v[66:67], v[74:75]
    v_cvt_pk_bf16_f32 v64, v64, v65
    v_cvt_pk_bf16_f32 v65, v66, v67
    buffer_store_dwordx2 v[64:65], v4, s[48:51], s57 offen sc1
    s_add_u32 m0, s64, 0x13000
    s_mul_i32 s56, s75, 172032
    buffer_load_dwordx4 v16, s[28:31], s56 offen lds
    s_add_u32 m0, s64, 0x14000
    s_mul_i32 s56, s76, 172032
    buffer_load_dwordx4 v16, s[28:31], s56 offen lds
    s_mov_b32 s8, s36
    s_mov_b32 s9, s37
    s_mul_i32 s10, s19, 1605632
    s_mov_b32 s11, 0x20000
    buffer_load_dword a248, v32, s[8:11], 0 offen offset:128
    s_waitcnt vmcnt(5)
    s_barrier
    ds_read_b64_tr_b16 a[0:1], v44 offset:0
    ds_read_b64_tr_b16 a[2:3], v44 offset:256
    ds_read_b64_tr_b16 a[4:5], v17 offset:0
    ds_read_b64_tr_b16 a[6:7], v17 offset:256
    ds_read_b64_tr_b16 a[8:9], v17 offset:1024
    ds_read_b64_tr_b16 a[10:11], v17 offset:1280
    ds_read_b64_tr_b16 a[12:13], v17 offset:2048
    ds_read_b64_tr_b16 a[14:15], v17 offset:2304
    ds_read_b64_tr_b16 a[16:17], v17 offset:3072
    ds_read_b64_tr_b16 a[18:19], v17 offset:3328
    s_waitcnt lgkmcnt(6)
    v_mfma_f32_32x32x16_bf16 a[40:55], v[40:43], a[0:3], 0
    ds_read_b64_tr_b16 a[20:21], v44 offset:4096
    ds_read_b64_tr_b16 a[22:23], v44 offset:4352
    v_mfma_f32_32x32x16_bf16 v[80:95], a[4:7], v[128:131], 0
    ds_read_b64_tr_b16 a[24:25], v17 offset:4096
    ds_read_b64_tr_b16 a[26:27], v17 offset:4352
    s_waitcnt lgkmcnt(6)
    v_mfma_f32_32x32x16_bf16 v[80:95], a[8:11], v[132:135], v[80:95]
    ds_read_b64_tr_b16 a[28:29], v17 offset:5120
    ds_read_b64_tr_b16 a[30:31], v17 offset:5376
    v_mfma_f32_32x32x16_bf16 v[80:95], a[12:15], v[136:139], v[80:95]
    ds_read_b64_tr_b16 a[0:1], v17 offset:6144
    ds_read_b64_tr_b16 a[2:3], v17 offset:6400
    v_mov_b32 v57, 0
    s_waitcnt lgkmcnt(6)
    v_mfma_f32_32x32x16_bf16 v[80:95], a[16:19], v[140:143], v[80:95]
    ds_read_b64_tr_b16 a[4:5], v17 offset:7168
    ds_read_b64_tr_b16 a[6:7], v17 offset:7424
    v_mov_b32 v58, 0
    v_mfma_f32_32x32x16_bf16 a[40:55], v[40:43], a[20:23], a[40:55]
    ds_read_b64_tr_b16 a[8:9], v44 offset:8192
    ds_read_b64_tr_b16 a[10:11], v44 offset:8448
    v_mov_b32 v59, 0
    s_waitcnt lgkmcnt(6)
    v_mfma_f32_32x32x16_bf16 v[80:95], a[24:27], v[144:147], v[80:95]
    ds_read_b64_tr_b16 a[12:13], v17 offset:8192
    ds_read_b64_tr_b16 a[14:15], v17 offset:8448
    v_mfma_f32_32x32x16_bf16 v[80:95], a[28:31], v[148:151], v[80:95]
    ds_read_b64_tr_b16 a[16:17], v17 offset:9216
    ds_read_b64_tr_b16 a[18:19], v17 offset:9472
    s_waitcnt lgkmcnt(6)
    v_mfma_f32_32x32x16_bf16 v[80:95], a[0:3], v[152:155], v[80:95]
    ds_read_b64_tr_b16 a[20:21], v17 offset:10240
    ds_read_b64_tr_b16 a[22:23], v17 offset:10496
    v_mfma_f32_32x32x16_bf16 v[80:95], a[4:7], v[156:159], v[80:95]
    ds_read_b64_tr_b16 a[24:25], v17 offset:11264
    ds_read_b64_tr_b16 a[26:27], v17 offset:11520
    s_waitcnt lgkmcnt(6)
    v_mfma_f32_32x32x16_bf16 a[40:55], v[40:43], a[8:11], a[40:55]
    ds_read_b64_tr_b16 a[28:29], v44 offset:12288
    ds_read_b64_tr_b16 a[30:31], v44 offset:12544
    v_mfma_f32_32x32x16_bf16 v[80:95], a[12:15], v[160:163], v[80:95]
    ds_read_b64_tr_b16 a[0:1], v17 offset:12288
    ds_read_b64_tr_b16 a[2:3], v17 offset:12544
    s_waitcnt lgkmcnt(6)
    v_mfma_f32_32x32x16_bf16 v[80:95], a[16:19], v[164:167], v[80:95]
    ds_read_b64_tr_b16 a[4:5], v17 offset:13312
    ds_read_b64_tr_b16 a[6:7], v17 offset:13568
    v_mfma_f32_32x32x16_bf16 v[80:95], a[20:23], v[168:171], v[80:95]
    ds_read_b64_tr_b16 a[8:9], v17 offset:14336
    ds_read_b64_tr_b16 a[10:11], v17 offset:14592
    s_waitcnt lgkmcnt(6)
    v_mfma_f32_32x32x16_bf16 v[80:95], a[24:27], v[172:175], v[80:95]
    ds_read_b64_tr_b16 a[12:13], v17 offset:15360
    ds_read_b64_tr_b16 a[14:15], v17 offset:15616
    v_mfma_f32_32x32x16_bf16 a[40:55], v[40:43], a[28:31], a[40:55]
    ds_read_b64_tr_b16 a[16:17], v44 offset:16384
    ds_read_b64_tr_b16 a[18:19], v44 offset:16640
    s_waitcnt lgkmcnt(6)
    v_mfma_f32_32x32x16_bf16 v[80:95], a[0:3], v[176:179], v[80:95]
    ds_read_b64_tr_b16 a[20:21], v17 offset:16384
    ds_read_b64_tr_b16 a[22:23], v17 offset:16640
    v_mfma_f32_32x32x16_bf16 v[80:95], a[4:7], v[180:183], v[80:95]
    ds_read_b64_tr_b16 a[24:25], v17 offset:17408
    ds_read_b64_tr_b16 a[26:27], v17 offset:17664
    s_waitcnt vmcnt(3)
    v_readfirstlane_b32 s3, v3
    s_nop 0
    s_cmp_ge_u32 s3, 16
    s_cbranch_scc1 L_ok0
    s_mov_b32 s58, 100000
L_spin0:
    buffer_load_dword v3, off, s[52:55], 0 sc1
    s_waitcnt vmcnt(0)
    v_readfirstlane_b32 s3, v3
    s_nop 0
    s_cmp_ge_u32 s3, 16
    s_cbranch_scc1 L_ok0
    s_sub_u32 s58, s58, 1
    s_cmp_lg_u32 s58, 0
    s_cbranch_scc1 L_spin0
L_ok0:
    s_mov_b64 exec, 1
    buffer_atomic_add v2, off, s[48:51], s59
    s_mov_b64 exec, -1
    s_waitcnt lgkmcnt(6)
    v_mfma_f32_32x32x16_bf16 v[80:95], a[8:11], v[184:187], v[80:95]
    s_lshl_b32 s6, s70, 13
    ds_read_b64_tr_b16 a[28:29], v17 offset:18432
    ds_read_b64_tr_b16 a[30:31], v17 offset:18688
    s_add_u32 s6, s6, s64
    s_add_u32 m0, s6, 0
    s_mul_i32 s56, s70, 57344
    buffer_load_dwordx4 v18, s[32:35], s56 offen lds
    v_mfma_f32_32x32x16_bf16 v[80:95], a[12:15], v[188:191], v[80:95]
    ds_read_b64_tr_b16 a[0:1], v17 offset:19456
    ds_read_b64_tr_b16 a[2:3], v17 offset:19712
    s_waitcnt lgkmcnt(6)
    v_mfma_f32_32x32x16_bf16 a[40:55], v[40:43], a[16:19], a[40:55]
    s_lshl_b32 s6, s70, 13
    s_waitcnt vmcnt(3)
    s_barrier
    ds_read_b64_tr_b16 a[4:5], v44 offset:20480
    ds_read_b64_tr_b16 a[6:7], v44 offset:20736
    s_add_u32 s6, s6, s64
    s_add_u32 m0, s6, 4096
    s_mul_i32 s56, s70, 57344
    s_add_u32 s56, s56, 28672
    buffer_load_dwordx4 v18, s[32:35], s56 offen lds
    v_mfma_f32_32x32x16_bf16 v[80:95], a[20:23], v[192:195], v[80:95]
    ds_read_b64_tr_b16 a[8:9], v17 offset:20480
    ds_read_b64_tr_b16 a[10:11], v17 offset:20736
    s_waitcnt lgkmcnt(6)
    v_mfma_f32_32x32x16_bf16 v[80:95], a[24:27], v[196:199], v[80:95]
    s_lshl_b32 s6, s71, 13
    ds_read_b64_tr_b16 a[12:13], v17 offset:21504
    ds_read_b64_tr_b16 a[14:15], v17 offset:21760
    s_add_u32 s6, s6, s64
    s_add_u32 m0, s6, 0
    s_mul_i32 s56, s71, 57344
    buffer_load_dwordx4 v18, s[32:35], s56 offen lds
    v_mfma_f32_32x32x16_bf16 v[80:95], a[28:31], v[200:203], v[80:95]
    ds_read_b64_tr_b16 a[16:17], v17 offset:22528
    ds_read_b64_tr_b16 a[18:19], v17 offset:22784
    s_waitcnt lgkmcnt(6)
    v_mfma_f32_32x32x16_bf16 v[80:95], a[0:3], v[204:207], v[80:95]
    s_lshl_b32 s6, s71, 13
    ds_read_b64_tr_b16 a[20:21], v17 offset:23552
    ds_read_b64_tr_b16 a[22:23], v17 offset:23808
    s_add_u32 s6, s6, s64
    s_add_u32 m0, s6, 4096
    s_mul_i32 s56, s71, 57344
    s_add_u32 s56, s56, 28672
    buffer_load_dwordx4 v18, s[32:35], s56 offen lds
    v_mfma_f32_32x32x16_bf16 a[40:55], v[40:43], a[4:7], a[40:55]
    ds_read_b64_tr_b16 a[24:25], v44 offset:24576
    ds_read_b64_tr_b16 a[26:27], v44 offset:24832
    s_waitcnt lgkmcnt(6)
    v_mfma_f32_32x32x16_bf16 v[80:95], a[8:11], v[208:211], v[80:95]
    s_lshl_b32 s6, s72, 13
    ds_read_b64_tr_b16 a[28:29], v17 offset:24576
    ds_read_b64_tr_b16 a[30:31], v17 offset:24832
    s_add_u32 s6, s6, s64
    s_add_u32 m0, s6, 0
    s_mul_i32 s56, s72, 57344
    buffer_load_dwordx4 v18, s[32:35], s56 offen lds
    v_mfma_f32_32x32x16_bf16 v[80:95], a[12:15], v[212:215], v[80:95]
    ds_read_b64_tr_b16 a[0:1], v17 offset:25600
    ds_read_b64_tr_b16 a[2:3], v17 offset:25856
    s_waitcnt lgkmcnt(6)
    v_mfma_f32_32x32x16_bf16 v[80:95], a[16:19], v[216:219], v[80:95]
    s_lshl_b32 s6, s72, 13
    ds_read_b64_tr_b16 a[4:5], v17 offset:26624
    ds_read_b64_tr_b16 a[6:7], v17 offset:26880
    s_add_u32 s6, s6, s64
    s_add_u32 m0, s6, 4096
    s_mul_i32 s56, s72, 57344
    s_add_u32 s56, s56, 28672
    buffer_load_dwordx4 v18, s[32:35], s56 offen lds
    v_mfma_f32_32x32x16_bf16 v[80:95], a[20:23], v[220:223], v[80:95]
    ds_read_b64_tr_b16 a[8:9], v17 offset:27648
    ds_read_b64_tr_b16 a[10:11], v17 offset:27904
    s_waitcnt lgkmcnt(6)
    v_mfma_f32_32x32x16_bf16 a[40:55], v[40:43], a[24:27], a[40:55]
    s_lshl_b32 s6, s73, 13
    s_add_u32 s6, s6, s64
    s_add_u32 m0, s6, 0
    s_mul_i32 s56, s73, 57344
    buffer_load_dwordx4 v18, s[32:35], s56 offen lds
    v_mfma_f32_32x32x16_bf16 v[80:95], a[28:31], v[224:227], v[80:95]
    s_waitcnt lgkmcnt(2)
    v_mfma_f32_32x32x16_bf16 v[80:95], a[0:3], v[228:231], v[80:95]
    s_lshl_b32 s6, s73, 13
    s_add_u32 s6, s6, s64
    s_add_u32 m0, s6, 4096
    s_mul_i32 s56, s73, 57344
    s_add_u32 s56, s56, 28672
    buffer_load_dwordx4 v18, s[32:35], s56 offen lds
    v_accvgpr_read_b32 v26, a40
    ds_write_b32 v30, v26
    v_mfma_f32_32x32x16_bf16 v[80:95], a[4:7], v[232:235], v[80:95]
    s_waitcnt lgkmcnt(0)
    s_barrier
    ds_read_b32 v60, v31 offset:0
    ds_read_b32 v61, v31 offset:128
    ds_read_b32 v62, v31 offset:256
    ds_read_b32 v63, v31 offset:384
    v_mfma_f32_32x32x16_bf16 v[80:95], a[8:11], v[236:239], v[80:95]
    s_waitcnt lgkmcnt(2)
    v_add_f32 v26, v60, v61
    s_waitcnt lgkmcnt(0)
    v_add_f32 v27, v62, v63
    v_add_f32 v26, v26, v27
    v_cvt_pk_bf16_f32 v27, v26, v26
    v_lshlrev_b32 v27, 16, v27
    v_sub_f32 v27, v26, v27
    v_cvt_pk_bf16_f32 v56, v26, v27
    s_nop 1
    v_mfma_f32_32x32x16_bf16 v[80:95], v[56:59], v[36:39], v[80:95]
    s_nop 11
    v_pk_mul_f32 v[240:241], v[80:81], v[254:255] op_sel_hi:[1,0]
    v_pk_mul_f32 v[242:243], v[82:83], v[254:255] op_sel_hi:[1,0]
    v_pk_mul_f32 v[80:81], v[80:81], v[252:253] op_sel_hi:[1,0]
    v_pk_mul_f32 v[82:83], v[82:83], v[252:253] op_sel_hi:[1,0]
    v_exp_f32 v240, v240 clamp
    v_exp_f32 v242, v242 clamp
    v_exp_f32 v241, v241 clamp
    v_exp_f32 v243, v243 clamp
    v_mov_b32 v3, 0
    s_mov_b64 exec, 1
    buffer_atomic_umax v3, off, s[48:51], s59 sc0
    s_mov_b64 exec, -1
    v_max_f32 v80, 0x358637bd, v80
    v_max_f32 v82, 0x358637bd, v82
    v_max_f32 v81, 0x358637bd, v81
    v_max_f32 v83, 0x358637bd, v83
    v_pk_add_f32 v[80:81], v[80:81], v[240:241]
    v_pk_add_f32 v[82:83], v[82:83], v[242:243]
    v_cvt_pk_bf16_f32 v32, v80, v81
    v_cvt_pk_bf16_f32 v33, v82, v83
    v_pk_mul_f32 v[240:241], v[84:85], v[254:255] op_sel_hi:[1,0]
    v_pk_mul_f32 v[242:243], v[86:87], v[254:255] op_sel_hi:[1,0]
    v_pk_mul_f32 v[84:85], v[84:85], v[252:253] op_sel_hi:[1,0]
    v_pk_mul_f32 v[86:87], v[86:87], v[252:253] op_sel_hi:[1,0]
    v_exp_f32 v240, v240 clamp
    v_exp_f32 v242, v242 clamp
    v_exp_f32 v241, v241 clamp
    v_exp_f32 v243, v243 clamp
    v_max_f32 v84, 0x358637bd, v84
    v_max_f32 v86, 0x358637bd, v86
    v_max_f32 v85, 0x358637bd, v85
    v_max_f32 v87, 0x358637bd, v87
    v_pk_add_f32 v[84:85], v[84:85], v[240:241]
    v_pk_add_f32 v[86:87], v[86:87], v[242:243]
    v_cvt_pk_bf16_f32 v34, v84, v85
    v_cvt_pk_bf16_f32 v35, v86, v87
    v_pk_mul_f32 v[240:241], v[88:89], v[254:255] op_sel_hi:[1,0]
    v_pk_mul_f32 v[242:243], v[90:91], v[254:255] op_sel_hi:[1,0]
    v_pk_mul_f32 v[88:89], v[88:89], v[252:253] op_sel_hi:[1,0]
    v_pk_mul_f32 v[90:91], v[90:91], v[252:253] op_sel_hi:[1,0]
    v_exp_f32 v240, v240 clamp
    v_exp_f32 v242, v242 clamp
    v_exp_f32 v241, v241 clamp
    v_exp_f32 v243, v243 clamp
    v_max_f32 v88, 0x358637bd, v88
    v_max_f32 v90, 0x358637bd, v90
    v_max_f32 v89, 0x358637bd, v89
    v_max_f32 v91, 0x358637bd, v91
    v_pk_add_f32 v[88:89], v[88:89], v[240:241]
    v_pk_add_f32 v[90:91], v[90:91], v[242:243]
    v_cvt_pk_bf16_f32 v36, v88, v89
    v_cvt_pk_bf16_f32 v37, v90, v91
    v_pk_mul_f32 v[240:241], v[92:93], v[254:255] op_sel_hi:[1,0]
    v_pk_mul_f32 v[242:243], v[94:95], v[254:255] op_sel_hi:[1,0]
    v_pk_mul_f32 v[92:93], v[92:93], v[252:253] op_sel_hi:[1,0]
    v_pk_mul_f32 v[94:95], v[94:95], v[252:253] op_sel_hi:[1,0]
    v_exp_f32 v240, v240 clamp
    v_exp_f32 v242, v242 clamp
    v_exp_f32 v241, v241 clamp
    v_exp_f32 v243, v243 clamp
    v_max_f32 v92, 0x358637bd, v92
    v_max_f32 v94, 0x358637bd, v94
    v_max_f32 v93, 0x358637bd, v93
    v_max_f32 v95, 0x358637bd, v95
    v_pk_add_f32 v[92:93], v[92:93], v[240:241]
    v_pk_add_f32 v[94:95], v[94:95], v[242:243]
    v_cvt_pk_bf16_f32 v38, v92, v93
    v_cvt_pk_bf16_f32 v39, v94, v95
    v_cndmask_b32 v38, v38, 0, s[14:15]
    v_cndmask_b32 v39, v39, 0, s[14:15]
    s_lshl_b32 s3, s61, 15
    s_lshl_b32 s4, s62, 9
    s_add_u32 s3, s3, s4
    s_add_u32 s57, s3, 131072
    s_lshl_b32 s5, s18, 13
    s_add_u32 s56, s57, s5
    v_mov_b32 v240, 0x3f80
    v_mov_b32 v241, 0x3f800000
    s_add_u32 s4, s4, 102400
    v_add_u32 v26, s4, v4
    v_add_u32 v27, 102400, v4
    s_lshl2_add_u32 s3, s60, s62
    s_lshl4_add_u32 s3, s3, s61
    s_lshl_b32 s3, s3, 11
    s_add_u32 s21, s3, 1179648
    s_lshl1_add_u32 s3, s62, s65
    s_lshl_b32 s3, s3, 7
    s_add_u32 s20, s3, s69
    v_mov_b32 v96, 0
    v_mov_b32 v97, 0
    v_mov_b32 v98, 0
    v_mov_b32 v99, 0
    s_waitcnt vmcnt(0)
    v_readfirstlane_b32 s3, v3
    s_nop 0
    s_cmp_ge_u32 s3, 16
    s_cbranch_scc1 L_ok1
    s_mov_b32 s58, 100000
L_spin1:
    s_mov_b64 exec, 1
    buffer_atomic_umax v3, off, s[48:51], s59 sc0
    s_mov_b64 exec, -1
    s_waitcnt vmcnt(0)
    v_readfirstlane_b32 s3, v3
    s_nop 0
    s_cmp_ge_u32 s3, 16
    s_cbranch_scc1 L_ok1
    s_sub_u32 s58, s58, 1
    s_cmp_lg_u32 s58, 0
    s_cbranch_scc1 L_spin1
L_ok1:
    buffer_load_dwordx2 v[64:65], v4, s[48:51], s56 offen sc1
    buffer_load_dwordx2 v[66:67], v4, s[48:51], s56 offen offset:2048 sc1
    s_add_u32 s5, s5, 4096
    s_and_b32 s5, s5, 0x7fff
    s_add_u32 s56, s57, s5
    buffer_load_dwordx2 v[68:69], v4, s[48:51], s56 offen sc1
    buffer_load_dwordx2 v[70:71], v4, s[48:51], s56 offen offset:2048 sc1
    s_add_u32 s5, s5, 4096
    s_and_b32 s5, s5, 0x7fff
    s_add_u32 s56, s57, s5
    buffer_load_dwordx2 v[72:73], v4, s[48:51], s56 offen sc1
    buffer_load_dwordx2 v[74:75], v4, s[48:51], s56 offen offset:2048 sc1
    s_add_u32 s5, s5, 4096
    s_and_b32 s5, s5, 0x7fff
    s_add_u32 s56, s57, s5
    buffer_load_dwordx2 v[76:77], v4, s[48:51], s56 offen sc1
    buffer_load_dwordx2 v[78:79], v4, s[48:51], s56 offen offset:2048 sc1
    s_add_u32 s5, s5, 4096
    s_and_b32 s5, s5, 0x7fff
    s_add_u32 s56, s57, s5
    buffer_load_dwordx2 v[80:81], v4, s[48:51], s56 offen sc1
    buffer_load_dwordx2 v[82:83], v4, s[48:51], s56 offen offset:2048 sc1
    s_add_u32 s5, s5, 4096
    s_and_b32 s5, s5, 0x7fff
    s_add_u32 s56, s57, s5
    buffer_load_dwordx2 v[84:85], v4, s[48:51], s56 offen sc1
    buffer_load_dwordx2 v[86:87], v4, s[48:51], s56 offen offset:2048 sc1
    s_add_u32 s5, s5, 4096
    s_and_b32 s5, s5, 0x7fff
    s_add_u32 s56, s57, s5
    buffer_load_dwordx2 v[88:89], v4, s[48:51], s56 offen sc1
    buffer_load_dwordx2 v[90:91], v4, s[48:51], s56 offen offset:2048 sc1
    s_add_u32 s5, s5, 4096
    s_and_b32 s5, s5, 0x7fff
    s_add_u32 s56, s57, s5
    buffer_load_dwordx2 v[92:93], v4, s[48:51], s56 offen sc1
    buffer_load_dwordx2 v[94:95], v4, s[48:51], s56 offen offset:2048 sc1
    v_add_u32 v128, 0, v20
    v_add_u32 v129, 57344, v20
    v_add_u32 v130, 114688, v20
    v_add_u32 v131, 172032, v20
    v_add_u32 v132, 128, v20
    v_add_u32 v133, 57472, v20
    v_add_u32 v134, 114816, v20
    v_add_u32 v135, 172160, v20
    s_mul_i32 s28, s70, 229376
    s_mul_i32 s29, s71, 229376
    s_mul_i32 s30, s72, 229376
    s_mul_i32 s31, s73, 229376
    s_mul_i32 s52, s74, 229376
    s_mul_i32 s53, s75, 229376
    s_mul_i32 s54, s76, 229376
    s_waitcnt vmcnt(15)
    v_dot2c_f32_bf16 v96, v64, v240
    v_dot2c_f32_bf16 v97, v64, v241
    v_dot2c_f32_bf16 v98, v65, v240
    v_dot2c_f32_bf16 v99, v65, v241
    s_waitcnt vmcnt(14)
    v_dot2c_f32_bf16 v96, v66, v240
    v_dot2c_f32_bf16 v97, v66, v241
    v_dot2c_f32_bf16 v98, v67, v240
    v_dot2c_f32_bf16 v99, v67, v241
    s_lshl1_add_u32 s6, s64, 0
    s_add_u32 m0, s6, 106496
    s_movk_i32 s56, 0
    buffer_load_dwordx4 v19, s[24:27], s56 offen lds
    s_waitcnt vmcnt(14)
    v_dot2c_f32_bf16 v96, v68, v240
    v_dot2c_f32_bf16 v97, v68, v241
    v_dot2c_f32_bf16 v98, v69, v240
    v_dot2c_f32_bf16 v99, v69, v241
    s_waitcnt vmcnt(13)
    v_dot2c_f32_bf16 v96, v70, v240
    v_dot2c_f32_bf16 v97, v70, v241
    v_dot2c_f32_bf16 v98, v71, v240
    s_lshl1_add_u32 s6, s64, 0
    s_add_u32 m0, s6, 107520
    s_movk_i32 s56, 14336
    buffer_load_dwordx4 v19, s[24:27], s56 offen lds
    v_dot2c_f32_bf16 v99, v71, v241
    s_waitcnt vmcnt(13)
    v_dot2c_f32_bf16 v96, v72, v240
    v_dot2c_f32_bf16 v97, v72, v241
    v_dot2c_f32_bf16 v98, v73, v240
    v_dot2c_f32_bf16 v99, v73, v241
    s_waitcnt vmcnt(12)
    v_dot2c_f32_bf16 v96, v74, v240
    v_dot2c_f32_bf16 v97, v74, v241
    s_add_u32 m0, s64, 0x1c000
    s_nop 0
    buffer_load_dwordx4 v128, s[36:39], s28 offen lds
    v_dot2c_f32_bf16 v98, v75, v240
    v_dot2c_f32_bf16 v99, v75, v241
    s_waitcnt vmcnt(12)
    v_dot2c_f32_bf16 v96, v76, v240
    v_dot2c_f32_bf16 v97, v76, v241
    v_dot2c_f32_bf16 v98, v77, v240
    v_dot2c_f32_bf16 v99, v77, v241
    s_waitcnt vmcnt(11)
    v_dot2c_f32_bf16 v96, v78, v240
    s_add_u32 m0, s64, 0x1d000
    s_nop 0
    buffer_load_dwordx4 v129, s[36:39], s28 offen lds
    v_dot2c_f32_bf16 v97, v78, v241
    v_dot2c_f32_bf16 v98, v79, v240
    v_dot2c_f32_bf16 v99, v79, v241
    s_waitcnt vmcnt(11)
    v_dot2c_f32_bf16 v96, v80, v240
    v_dot2c_f32_bf16 v97, v80, v241
    v_dot2c_f32_bf16 v98, v81, v240
    v_dot2c_f32_bf16 v99, v81, v241
    s_add_u32 m0, s64, 0x1e000
    s_nop 0
    buffer_load_dwordx4 v130, s[36:39], s28 offen lds
    s_waitcnt vmcnt(11)
    v_dot2c_f32_bf16 v96, v82, v240
    v_dot2c_f32_bf16 v97, v82, v241
    v_dot2c_f32_bf16 v98, v83, v240
    v_dot2c_f32_bf16 v99, v83, v241
    s_waitcnt vmcnt(10)
    v_dot2c_f32_bf16 v96, v84, v240
    v_dot2c_f32_bf16 v97, v84, v241
    v_dot2c_f32_bf16 v98, v85, v240
    s_add_u32 m0, s64, 0x1f000
    s_nop 0
    buffer_load_dwordx4 v131, s[36:39], s28 offen lds
    v_dot2c_f32_bf16 v99, v85, v241
    s_waitcnt vmcnt(10)
    v_dot2c_f32_bf16 v96, v86, v240
    v_dot2c_f32_bf16 v97, v86, v241
    v_dot2c_f32_bf16 v98, v87, v240
    v_dot2c_f32_bf16 v99, v87, v241
    s_waitcnt vmcnt(9)
    v_dot2c_f32_bf16 v96, v88, v240
    v_dot2c_f32_bf16 v97, v88, v241
    s_add_u32 m0, s64, 0x20000
    s_nop 0
    buffer_load_dwordx4 v128, s[36:39], s29 offen lds
    v_dot2c_f32_bf16 v98, v89, v240
    v_dot2c_f32_bf16 v99, v89, v241
    s_waitcnt vmcnt(9)
    v_dot2c_f32_bf16 v96, v90, v240
    v_dot2c_f32_bf16 v97, v90, v241
    v_dot2c_f32_bf16 v98, v91, v240
    v_dot2c_f32_bf16 v99, v91, v241
    s_waitcnt vmcnt(8)
    v_dot2c_f32_bf16 v96, v92, v240
    s_add_u32 m0, s64, 0x21000
    s_nop 0
    buffer_load_dwordx4 v129, s[36:39], s29 offen lds
    v_dot2c_f32_bf16 v97, v92, v241
    v_dot2c_f32_bf16 v98, v93, v240
    v_dot2c_f32_bf16 v99, v93, v241
    s_waitcnt vmcnt(8)
    v_dot2c_f32_bf16 v96, v94, v240
    v_dot2c_f32_bf16 v97, v94, v241
    v_dot2c_f32_bf16 v98, v95, v240
    v_dot2c_f32_bf16 v99, v95, v241
    s_nop 0
    v_cvt_pk_bf16_f32 v64, v96, v97
    s_nop 0
    v_cvt_pk_bf16_f32 v65, v98, v99
    ds_write_b64 v26, v[64:65]
    s_waitcnt lgkmcnt(0)
    s_barrier
    ds_read_b64 v[40:41], v27 offset:0
    ds_read_b64 v[42:43], v27 offset:512
    ds_read_b64 v[44:45], v27 offset:1024
    ds_read_b64 v[46:47], v27 offset:1536
    s_waitcnt lgkmcnt(2)
    v_mfma_f32_32x32x16_bf16 v[80:95], v[40:43], v[32:35], 0
    s_waitcnt lgkmcnt(0)
    v_mfma_f32_32x32x16_bf16 v[80:95], v[44:47], v[36:39], v[80:95]
    s_nop 11
    v_mov_b32 v29, v92
    s_nop 1
    v_permlane32_swap_b32 v92, v29
    v_add_f32 v29, 0x358637bd, v29
    v_rcp_f32 v240, v29
    s_nop 0
    v_cndmask_b32 v242, v240, 0, s[14:15]
    v_pk_mul_f32 v[80:81], v[80:81], v[240:241] op_sel_hi:[1,0]
    v_pk_mul_f32 v[82:83], v[82:83], v[240:241] op_sel_hi:[1,0]
    v_pk_mul_f32 v[84:85], v[84:85], v[240:241] op_sel_hi:[1,0]
    v_pk_mul_f32 v[86:87], v[86:87], v[240:241] op_sel_hi:[1,0]
    v_cvt_pk_bf16_f32 v64, v80, v81
    v_cvt_pk_bf16_f32 v65, v82, v83
    v_cvt_pk_bf16_f32 v66, v84, v85
    v_cvt_pk_bf16_f32 v67, v86, v87
    buffer_store_dwordx4 v[64:67], v1, s[48:51], s21 offen sc1
    v_pk_mul_f32 v[88:89], v[88:89], v[240:241] op_sel_hi:[1,0]
    v_pk_mul_f32 v[90:91], v[90:91], v[240:241] op_sel_hi:[1,0]
    v_pk_mul_f32 v[92:93], v[92:93], v[242:243] op_sel_hi:[1,0]
    v_pk_mul_f32 v[94:95], v[94:95], v[242:243] op_sel_hi:[1,0]
    v_cvt_pk_bf16_f32 v68, v88, v89
    v_cvt_pk_bf16_f32 v69, v90, v91
    v_cvt_pk_bf16_f32 v70, v92, v93
    v_cvt_pk_bf16_f32 v71, v94, v95
    buffer_store_dwordx4 v[68:71], v1, s[48:51], s21 offen offset:1024 sc1
    s_cmp_ge_u32 s63, 7
    s_cbranch_scc1 L_idle
    s_lshl1_add_u32 s3, s22, s68
    s_lshl_b32 s3, s3, 7
    s_add_u32 s59, s3, s69
    s_lshl2_add_u32 s3, s60, s22
    s_lshl1_add_u32 s4, s3, s68
    s_lshl_b32 s4, s4, 14
    s_add_u32 s57, s4, 1179648
    s_lshl1_add_u32 s4, s63, s68
    s_lshl4_add_u32 s3, s3, s4
    s_lshl_b32 s4, s3, 11
    s_add_u32 s11, s4, 3276800
    s_lshl_b32 s4, s3, 8
    s_add_u32 s12, s4, 5373952
    s_lshl_b32 s3, s62, 11
    s_add_u32 s3, s3, 106496
    v_and_b32 v28, 31, v0
    v_lshrrev_b32 v29, 5, v0
    v_lshlrev_b32 v29, 3, v29
    v_lshl_add_u32 v29, v28, 6, v29
    v_add_u32 v29, s3, v29
    v_lshlrev_b32 v4, 3, v28
    s_lshl_b32 s3, s62, 12
    s_add_u32 s3, s3, 86016
    v_add_u32 v26, s3, v1
    s_xor_b32 s4, s62, 2
    s_lshl_b32 s4, s4, 12
    s_add_u32 s4, s4, 86016
    v_add_u32 v27, s4, v1
    s_waitcnt vmcnt(0)
    s_mov_b64 exec, 1
    buffer_atomic_add v2, off, s[48:51], s20
    s_mov_b64 exec, -1
    s_lshl_b32 s6, s74, 13
    s_add_u32 s6, s6, s64
    s_add_u32 m0, s6, 0
    s_mul_i32 s56, s74, 57344
    buffer_load_dwordx4 v18, s[32:35], s56 offen lds
    s_lshl_b32 s6, s74, 13
    s_add_u32 s6, s6, s64
    s_add_u32 m0, s6, 4096
    s_mul_i32 s56, s74, 57344
    s_add_u32 s56, s56, 28672
    buffer_load_dwordx4 v18, s[32:35], s56 offen lds
    s_lshl_b32 s6, s75, 13
    s_add_u32 s6, s6, s64
    s_add_u32 m0, s6, 0
    s_mul_i32 s56, s75, 57344
    buffer_load_dwordx4 v18, s[32:35], s56 offen lds
    s_lshl_b32 s6, s75, 13
    s_add_u32 s6, s6, s64
    s_add_u32 m0, s6, 4096
    s_mul_i32 s56, s75, 57344
    s_add_u32 s56, s56, 28672
    buffer_load_dwordx4 v18, s[32:35], s56 offen lds
    s_lshl_b32 s6, s76, 13
    s_add_u32 s6, s6, s64
    s_add_u32 m0, s6, 0
    s_mul_i32 s56, s76, 57344
    buffer_load_dwordx4 v18, s[32:35], s56 offen lds
    s_lshl_b32 s6, s76, 13
    s_add_u32 s6, s6, s64
    s_add_u32 m0, s6, 4096
    s_mul_i32 s56, s76, 57344
    s_add_u32 s56, s56, 28672
    buffer_load_dwordx4 v18, s[32:35], s56 offen lds
    s_add_u32 m0, s64, 0x22000
    s_nop 0
    buffer_load_dwordx4 v130, s[36:39], s29 offen lds
    s_add_u32 m0, s64, 0x23000
    s_nop 0
    buffer_load_dwordx4 v131, s[36:39], s29 offen lds
    s_add_u32 m0, s64, 0x24000
    s_nop 0
    buffer_load_dwordx4 v128, s[36:39], s30 offen lds
    s_add_u32 m0, s64, 0x25000
    s_nop 0
    buffer_load_dwordx4 v129, s[36:39], s30 offen lds
    s_add_u32 m0, s64, 0x26000
    s_nop 0
    buffer_load_dwordx4 v130, s[36:39], s30 offen lds
    s_add_u32 m0, s64, 0x27000
    s_nop 0
    buffer_load_dwordx4 v131, s[36:39], s30 offen lds
    s_add_u32 m0, s64, 0xe000
    s_nop 0
    buffer_load_dwordx4 v128, s[36:39], s31 offen lds
    s_add_u32 m0, s64, 0xf000
    s_nop 0
    buffer_load_dwordx4 v129, s[36:39], s31 offen lds
    v_mov_b32 v3, 0
    s_mov_b64 exec, 1
    buffer_atomic_umax v3, off, s[48:51], s59 sc0
    s_mov_b64 exec, -1
    ds_read_b64 v[32:33], v29 offset:0
    ds_read_b64 v[34:35], v29 offset:16
    ds_read_b64 v[36:37], v29 offset:32
    ds_read_b64 v[38:39], v29 offset:48
    s_waitcnt lgkmcnt(3)
    v_lshlrev_b32 v64, 16, v32
    v_and_b32 v65, 0xffff0000, v32
    v_lshlrev_b32 v66, 16, v33
    v_and_b32 v67, 0xffff0000, v33
    s_waitcnt lgkmcnt(2)
    v_lshlrev_b32 v68, 16, v34
    v_and_b32 v69, 0xffff0000, v34
    v_lshlrev_b32 v70, 16, v35
    v_and_b32 v71, 0xffff0000, v35
    s_waitcnt lgkmcnt(1)
    v_lshlrev_b32 v72, 16, v36
    v_and_b32 v73, 0xffff0000, v36
    v_lshlrev_b32 v74, 16, v37
    v_and_b32 v75, 0xffff0000, v37
    s_waitcnt lgkmcnt(0)
    v_lshlrev_b32 v76, 16, v38
    v_and_b32 v77, 0xffff0000, v38
    v_lshlrev_b32 v78, 16, v39
    v_and_b32 v79, 0xffff0000, v39
    s_lshl_b32 s3, s22, 7
    s_add_u32 s3, s3, s69
    s_add_u32 s20, s3, 1024
    v_mov_b32 v248, 0
    v_mov_b32 v249, 0
    s_mul_i32 s3, s68, 26624
    v_subrev_u32 v14, s3, v22
    v_subrev_u32 v15, s3, v23
    s_mul_i32 s3, s63, 3584
    v_add_u32 v22, s3, v22
    v_add_u32 v23, s3, v23
    v_add_u32 v24, s3, v24
    v_add_u32 v25, s3, v25
    s_lshl_b32 s7, s63, 11
    s_sub_u32 s7, s7, 2048
    s_mov_b32 s6, -25088
    s_waitcnt vmcnt(0)
    v_readfirstlane_b32 s3, v3
    s_nop 0
    s_cmp_ge_u32 s3, 8
    s_cbranch_scc1 L_ok2
    s_mov_b32 s58, 100000
L_spin2:
    s_mov_b64 exec, 1
    buffer_atomic_umax v3, off, s[48:51], s59 sc0
    s_mov_b64 exec, -1
    s_waitcnt vmcnt(0)
    v_readfirstlane_b32 s3, v3
    s_nop 0
    s_cmp_ge_u32 s3, 8
    s_cbranch_scc1 L_ok2
    s_sub_u32 s58, s58, 1
    s_cmp_lg_u32 s58, 0
    s_cbranch_scc1 L_spin2
L_ok2:
    s_add_u32 s7, s7, 2048
    s_and_b32 s7, s7, 0x3fff
    s_add_u32 s56, s7, s57
    buffer_load_dwordx4 a[40:43], v1, s[48:51], s56 offen sc1
    buffer_load_dwordx4 a[44:47], v1, s[48:51], s56 offen offset:1024 sc1
    s_add_u32 s7, s7, 2048
    s_and_b32 s7, s7, 0x3fff
    s_add_u32 s56, s7, s57
    buffer_load_dwordx4 a[48:51], v1, s[48:51], s56 offen sc1
    buffer_load_dwordx4 a[52:55], v1, s[48:51], s56 offen offset:1024 sc1
    s_add_u32 s7, s7, 2048
    s_and_b32 s7, s7, 0x3fff
    s_add_u32 s56, s7, s57
    buffer_load_dwordx4 a[56:59], v1, s[48:51], s56 offen sc1
    buffer_load_dwordx4 a[60:63], v1, s[48:51], s56 offen offset:1024 sc1
    s_add_u32 s7, s7, 2048
    s_and_b32 s7, s7, 0x3fff
    s_add_u32 s56, s7, s57
    buffer_load_dwordx4 a[64:67], v1, s[48:51], s56 offen sc1
    buffer_load_dwordx4 a[68:71], v1, s[48:51], s56 offen offset:1024 sc1
    s_barrier
    ds_read_b64_tr_b16 a[0:1], v22 offset:0
    ds_read_b64_tr_b16 a[2:3], v22 offset:1024
    ds_read_b64_tr_b16 a[4:5], v23 offset:0
    ds_read_b64_tr_b16 a[6:7], v23 offset:1024
    ds_read_b64_tr_b16 a[8:9], v22 offset:2048
    ds_read_b64_tr_b16 a[10:11], v24 offset:3072
    ds_read_b64_tr_b16 a[12:13], v23 offset:2048
    ds_read_b64_tr_b16 a[14:15], v25 offset:3072
    s_cmp_eq_u32 s63, 7
    s_cselect_b32 s5, s6, 3584
    v_add_u32 v22, s5, v22
    ds_read_b64_tr_b16 a[16:17], v22 offset:0
    ds_read_b64_tr_b16 a[18:19], v22 offset:1024
    v_add_u32 v23, s5, v23
    ds_read_b64_tr_b16 a[20:21], v23 offset:0
    ds_read_b64_tr_b16 a[22:23], v23 offset:1024
    v_add_u32 v24, s5, v24
    ds_read_b64_tr_b16 a[24:25], v22 offset:2048
    ds_read_b64_tr_b16 a[26:27], v24 offset:3072
    s_waitcnt vmcnt(7) lgkmcnt(6)
    v_mfma_f32_32x32x16_bf16 v[64:79], a[0:3], a[40:43], v[64:79]
    v_add_u32 v25, s5, v25
    ds_read_b64_tr_b16 a[28:29], v23 offset:2048
    ds_read_b64_tr_b16 a[30:31], v25 offset:3072
    s_add_u32 s7, s7, 2048
    s_and_b32 s7, s7, 0x3fff
    s_add_u32 s56, s7, s57
    buffer_load_dwordx4 a[72:75], v1, s[48:51], s56 offen sc1
    v_mfma_f32_32x32x16_bf16 v[80:95], a[4:7], a[40:43], 0
    s_cmp_eq_u32 s63, 6
    s_cselect_b32 s5, s6, 3584
    v_add_u32 v22, s5, v22
    ds_read_b64_tr_b16 a[0:1], v22 offset:0
    ds_read_b64_tr_b16 a[2:3], v22 offset:1024
    buffer_load_dwordx4 a[76:79], v1, s[48:51], s56 offen offset:1024 sc1
    s_waitcnt vmcnt(8)
    v_mfma_f32_32x32x16_bf16 v[64:79], a[8:11], a[44:47], v[64:79]
    v_add_u32 v23, s5, v23
    ds_read_b64_tr_b16 a[4:5], v23 offset:0
    ds_read_b64_tr_b16 a[6:7], v23 offset:1024
    s_add_u32 s7, s7, 2048
    s_and_b32 s7, s7, 0x3fff
    s_add_u32 s56, s7, s57
    buffer_load_dwordx4 a[80:83], v1, s[48:51], s56 offen sc1
    v_mfma_f32_32x32x16_bf16 v[80:95], a[12:15], a[44:47], v[80:95]
    v_add_u32 v24, s5, v24
    ds_read_b64_tr_b16 a[8:9], v22 offset:2048
    ds_read_b64_tr_b16 a[10:11], v24 offset:3072
    buffer_load_dwordx4 a[84:87], v1, s[48:51], s56 offen offset:1024 sc1
    s_waitcnt vmcnt(9) lgkmcnt(6)
    v_mfma_f32_32x32x16_bf16 v[64:79], a[16:19], a[48:51], v[64:79]
    v_add_u32 v25, s5, v25
    ds_read_b64_tr_b16 a[12:13], v23 offset:2048
    ds_read_b64_tr_b16 a[14:15], v25 offset:3072
    s_add_u32 s7, s7, 2048
    s_and_b32 s7, s7, 0x3fff
    s_add_u32 s56, s7, s57
    buffer_load_dwordx4 a[88:91], v1, s[48:51], s56 offen sc1
    v_mfma_f32_32x32x16_bf16 v[80:95], a[20:23], a[48:51], v[80:95]
    s_cmp_eq_u32 s63, 5
    s_cselect_b32 s5, s6, 3584
    v_add_u32 v22, s5, v22
    ds_read_b64_tr_b16 a[16:17], v22 offset:0
    ds_read_b64_tr_b16 a[18:19], v22 offset:1024
    buffer_load_dwordx4 a[92:95], v1, s[48:51], s56 offen offset:1024 sc1
    s_waitcnt vmcnt(10)
    v_mfma_f32_32x32x16_bf16 v[64:79], a[24:27], a[52:55], v[64:79]
    v_add_u32 v23, s5, v23
    ds_read_b64_tr_b16 a[20:21], v23 offset:0
    ds_read_b64_tr_b16 a[22:23], v23 offset:1024
    s_add_u32 s7, s7, 2048
    s_and_b32 s7, s7, 0x3fff
    s_add_u32 s56, s7, s57
    buffer_load_dwordx4 a[96:99], v1, s[48:51], s56 offen sc1
    v_mfma_f32_32x32x16_bf16 v[80:95], a[28:31], a[52:55], v[80:95]
    v_add_u32 v24, s5, v24
    ds_read_b64_tr_b16 a[24:25], v22 offset:2048
    ds_read_b64_tr_b16 a[26:27], v24 offset:3072
    buffer_load_dwordx4 a[100:103], v1, s[48:51], s56 offen offset:1024 sc1
    s_waitcnt vmcnt(11) lgkmcnt(6)
    v_mfma_f32_32x32x16_bf16 v[64:79], a[0:3], a[56:59], v[64:79]
    v_add_u32 v25, s5, v25
    ds_read_b64_tr_b16 a[28:29], v23 offset:2048
    ds_read_b64_tr_b16 a[30:31], v25 offset:3072
    v_mfma_f32_32x32x16_bf16 v[80:95], a[4:7], a[56:59], v[80:95]
    s_add_u32 m0, s64, 0x10000
    s_cmp_eq_u32 s63, 4
    s_cselect_b32 s5, s6, 3584
    v_add_u32 v22, s5, v22
    ds_read_b64_tr_b16 a[0:1], v22 offset:0
    ds_read_b64_tr_b16 a[2:3], v22 offset:1024
    buffer_load_dwordx4 v130, s[36:39], s31 offen lds
    s_waitcnt vmcnt(11)
    v_mfma_f32_32x32x16_bf16 v[64:79], a[8:11], a[60:63], v[64:79]
    v_add_u32 v23, s5, v23
    ds_read_b64_tr_b16 a[4:5], v23 offset:0
    ds_read_b64_tr_b16 a[6:7], v23 offset:1024
    v_mfma_f32_32x32x16_bf16 v[80:95], a[12:15], a[60:63], v[80:95]
    v_add_u32 v24, s5, v24
    ds_read_b64_tr_b16 a[8:9], v22 offset:2048
    ds_read_b64_tr_b16 a[10:11], v24 offset:3072
    s_waitcnt vmcnt(10) lgkmcnt(6)
    v_mfma_f32_32x32x16_bf16 v[64:79], a[16:19], a[64:67], v[64:79]
    s_add_u32 m0, s64, 0x11000
    v_add_u32 v25, s5, v25
    ds_read_b64_tr_b16 a[12:13], v23 offset:2048
    ds_read_b64_tr_b16 a[14:15], v25 offset:3072
    buffer_load_dwordx4 v131, s[36:39], s31 offen lds
    v_mfma_f32_32x32x16_bf16 v[80:95], a[20:23], a[64:67], v[80:95]
    s_cmp_eq_u32 s63, 3
    s_cselect_b32 s5, s6, 3584
    v_add_u32 v22, s5, v22
    ds_read_b64_tr_b16 a[16:17], v22 offset:0
    ds_read_b64_tr_b16 a[18:19], v22 offset:1024
    s_waitcnt vmcnt(10)
    v_mfma_f32_32x32x16_bf16 v[64:79], a[24:27], a[68:71], v[64:79]
    v_add_u32 v23, s5, v23
    ds_read_b64_tr_b16 a[20:21], v23 offset:0
    ds_read_b64_tr_b16 a[22:23], v23 offset:1024
    v_mfma_f32_32x32x16_bf16 v[80:95], a[28:31], a[68:71], v[80:95]
    v_add_u32 v24, s5, v24
    ds_read_b64_tr_b16 a[24:25], v22 offset:2048
    ds_read_b64_tr_b16 a[26:27], v24 offset:3072
    s_waitcnt vmcnt(9) lgkmcnt(6)
    v_mfma_f32_32x32x16_bf16 v[64:79], a[0:3], a[72:75], v[64:79]
    s_add_u32 m0, s64, 0x12000
    v_add_u32 v25, s5, v25
    ds_read_b64_tr_b16 a[28:29], v23 offset:2048
    ds_read_b64_tr_b16 a[30:31], v25 offset:3072
    buffer_load_dwordx4 v128, s[36:39], s52 offen lds
    v_mfma_f32_32x32x16_bf16 v[80:95], a[4:7], a[72:75], v[80:95]
    s_cmp_eq_u32 s63, 2
    s_cselect_b32 s5, s6, 3584
    v_add_u32 v23, s5, v23
    ds_read_b64_tr_b16 a[0:1], v23 offset:0
    ds_read_b64_tr_b16 a[2:3], v23 offset:1024
    s_waitcnt vmcnt(9)
    v_mfma_f32_32x32x16_bf16 v[64:79], a[8:11], a[76:79], v[64:79]
    v_add_u32 v25, s5, v25
    ds_read_b64_tr_b16 a[4:5], v23 offset:2048
    ds_read_b64_tr_b16 a[6:7], v25 offset:3072
    v_mfma_f32_32x32x16_bf16 v[80:95], a[12:15], a[76:79], v[80:95]
    s_add_u32 m0, s64, 0x13000
    s_cmp_eq_u32 s63, 1
    s_cselect_b32 s5, s6, 3584
    v_add_u32 v23, s5, v23
    ds_read_b64_tr_b16 a[8:9], v23 offset:0
    ds_read_b64_tr_b16 a[10:11], v23 offset:1024
    buffer_load_dwordx4 v129, s[36:39], s52 offen lds
    s_waitcnt vmcnt(9) lgkmcnt(6)
    v_mfma_f32_32x32x16_bf16 v[64:79], a[16:19], a[80:83], v[64:79]
    v_add_u32 v25, s5, v25
    ds_read_b64_tr_b16 a[12:13], v23 offset:2048
    ds_read_b64_tr_b16 a[14:15], v25 offset:3072
    v_mfma_f32_32x32x16_bf16 v[80:95], a[20:23], a[80:83], v[80:95]
    s_cmp_eq_u32 s63, 2
    s_cselect_b32 s5, s6, 3584
    v_add_u32 v22, s5, v22
    ds_read_b64_tr_b16 a[16:17], v22 offset:0
    ds_read_b64_tr_b16 a[18:19], v22 offset:1024
    s_waitcnt vmcnt(8)
    v_mfma_f32_32x32x16_bf16 v[64:79], a[24:27], a[84:87], v[64:79]
    v_add_u32 v24, s5, v24
    ds_read_b64_tr_b16 a[20:21], v22 offset:2048
    ds_read_b64_tr_b16 a[22:23], v24 offset:3072
    v_mfma_f32_32x32x16_bf16 v[80:95], a[28:31], a[84:87], v[80:95]
    s_add_u32 m0, s64, 0x14000
    s_cmp_eq_u32 s63, 1
    s_cselect_b32 s5, s6, 3584
    v_add_u32 v22, s5, v22
    ds_read_b64_tr_b16 a[24:25], v22 offset:0
    ds_read_b64_tr_b16 a[26:27], v22 offset:1024
    buffer_load_dwordx4 v130, s[36:39], s52 offen lds
    s_waitcnt vmcnt(8) lgkmcnt(6)
    v_mfma_f32_32x32x16_bf16 v[80:95], a[0:3], a[88:91], v[80:95]
    v_add_u32 v24, s5, v24
    ds_read_b64_tr_b16 a[28:29], v22 offset:2048
    ds_read_b64_tr_b16 a[30:31], v24 offset:3072
    s_waitcnt vmcnt(7)
    v_mfma_f32_32x32x16_bf16 v[80:95], a[4:7], a[92:95], v[80:95]
    s_waitcnt vmcnt(6)
    v_mfma_f32_32x32x16_bf16 v[80:95], a[8:11], a[96:99], v[80:95]
    s_waitcnt vmcnt(5)
    v_mfma_f32_32x32x16_bf16 v[80:95], a[12:15], a[100:103], v[80:95]
    s_waitcnt lgkmcnt(0)
    v_mfma_f32_32x32x16_bf16 v[64:79], a[16:19], a[88:91], v[64:79]
    v_mfma_f32_32x32x16_bf16 v[64:79], a[20:23], a[92:95], v[64:79]
    s_nop 8
    ds_write_b128 v26, v[80:83] offset:0
    ds_write_b128 v26, v[84:87] offset:1024
    ds_write_b128 v26, v[88:91] offset:2048
    ds_write_b128 v26, v[92:95] offset:3072
    v_mfma_f32_32x32x16_bf16 v[64:79], a[24:27], a[96:99], v[64:79]
    v_mfma_f32_32x32x16_bf16 v[64:79], a[28:31], a[100:103], v[64:79]
    s_waitcnt lgkmcnt(0)
    s_barrier
    ds_read_b128 v[96:99], v27 offset:0
    ds_read_b128 v[100:103], v27 offset:1024
    ds_read_b128 v[104:107], v27 offset:2048
    ds_read_b128 v[108:111], v27 offset:3072
    s_waitcnt lgkmcnt(3)
    s_nop 4
    v_pk_add_f32 v[64:65], v[64:65], v[96:97]
    v_pk_add_f32 v[66:67], v[66:67], v[98:99]
    s_waitcnt lgkmcnt(2)
    v_pk_add_f32 v[68:69], v[68:69], v[100:101]
    v_pk_add_f32 v[70:71], v[70:71], v[102:103]
    v_cvt_pk_bf16_f32 v32, v64, v65
    v_cvt_pk_bf16_f32 v33, v66, v67
    v_cvt_pk_bf16_f32 v34, v68, v69
    v_cvt_pk_bf16_f32 v35, v70, v71
    buffer_store_dwordx4 v[32:35], v1, s[48:51], s11 offen sc1
    s_waitcnt lgkmcnt(1)
    v_pk_add_f32 v[72:73], v[72:73], v[104:105]
    v_pk_add_f32 v[74:75], v[74:75], v[106:107]
    s_waitcnt lgkmcnt(0)
    v_pk_add_f32 v[76:77], v[76:77], v[108:109]
    v_pk_add_f32 v[78:79], v[78:79], v[110:111]
    v_cvt_pk_bf16_f32 v36, v72, v73
    v_cvt_pk_bf16_f32 v37, v74, v75
    v_cvt_pk_bf16_f32 v38, v76, v77
    v_cvt_pk_bf16_f32 v39, v78, v79
    buffer_store_dwordx4 v[36:39], v1, s[48:51], s11 offen offset:1024 sc1
    v_dot2c_f32_bf16 v248, v32, v250
    v_dot2c_f32_bf16 v249, v32, v32
    v_dot2c_f32_bf16 v248, v33, v250
    v_dot2c_f32_bf16 v249, v33, v33
    v_dot2c_f32_bf16 v248, v34, v250
    v_dot2c_f32_bf16 v249, v34, v34
    v_dot2c_f32_bf16 v248, v35, v250
    v_dot2c_f32_bf16 v249, v35, v35
    v_dot2c_f32_bf16 v248, v36, v250
    v_dot2c_f32_bf16 v249, v36, v36
    v_dot2c_f32_bf16 v248, v37, v250
    v_dot2c_f32_bf16 v249, v37, v37
    v_dot2c_f32_bf16 v248, v38, v250
    v_dot2c_f32_bf16 v249, v38, v38
    v_dot2c_f32_bf16 v248, v39, v250
    v_dot2c_f32_bf16 v249, v39, v39
    s_nop 1
    v_mov_b32 v28, v248
    v_mov_b32 v29, v249
    s_nop 0
    v_permlane32_swap_b32 v28, v248
    v_permlane32_swap_b32 v29, v249
    v_add_f32 v248, v28, v248
    v_add_f32 v249, v29, v249
    buffer_store_dwordx2 v[248:249], v4, s[48:51], s12 offen sc1
    v_accvgpr_write_b32 a32, v32
    v_accvgpr_write_b32 a33, v33
    v_accvgpr_write_b32 a34, v34
    v_accvgpr_write_b32 a35, v35
    v_accvgpr_write_b32 a36, v36
    v_accvgpr_write_b32 a37, v37
    v_accvgpr_write_b32 a38, v38
    v_accvgpr_write_b32 a39, v39
    v_bfe_u32 v240, v0, 2, 2
    v_bfe_u32 v241, v0, 4, 1
    v_lshrrev_b32 v242, 5, v0
    v_lshl_add_u32 v28, v242, 2, v240
    v_lshlrev_b32 v28, 7, v28
    v_lshl_add_u32 v28, v241, 11, v28
    v_and_b32 v29, 1, v0
    v_lshl_add_u32 v28, v29, 3, v28
    v_lshrrev_b32 v29, 1, v240
    v_lshl_add_u32 v29, v241, 1, v29
    v_lshlrev_b32 v29, 1, v29
    v_bfe_u32 v30, v0, 1, 1
    v_xor_b32 v29, v29, v30
    v_xor_b32 v30, 0, v29
    v_lshl_add_u32 v9, v30, 4, v28
    v_xor_b32 v30, 2, v29
    v_lshl_add_u32 v10, v30, 4, v28
    v_xor_b32 v30, 4, v29
    v_lshl_add_u32 v11, v30, 4, v28
    v_xor_b32 v30, 6, v29
    v_lshl_add_u32 v12, v30, 4, v28
    s_movk_i32 s3, 1792
    v_mad_u32_u24 v30, v242, s3, v4
    v_lshlrev_b32 v4, 1, v4
    s_lshl2_add_u32 s3, s60, s62
    s_lshl_b32 s4, s3, 12
    s_add_u32 s10, s4, 5373952
    s_lshl_b32 s4, s3, 15
    s_add_u32 s8, s4, 3276800
    s_mul_i32 s3, s3, 14
    s_add_u32 s3, s3, s66
    s_lshl_b32 s3, s3, 13
    s_add_u32 s13, s3, 5636096
    s_lshl_b32 s3, s62, 7
    s_add_u32 s3, s3, s69
    s_add_u32 s59, s3, 1024
    s_lshl_b32 s3, s66, 13
    s_add_u32 s7, s3, 6144
    s_waitcnt vmcnt(0)
    s_barrier
    s_cmp_ge_u32 s62, 2
    s_cbranch_scc1 L_nohs
    s_mov_b64 exec, 1
    buffer_atomic_add v2, off, s[48:51], s20
    s_mov_b64 exec, -1
L_nohs:
    s_add_u32 m0, s64, 0x0
    s_nop 0
    buffer_load_dwordx4 v131, s[36:39], s52 offen lds
    s_add_u32 m0, s64, 0x1000
    s_nop 0
    buffer_load_dwordx4 v128, s[36:39], s53 offen lds
    s_add_u32 m0, s64, 0x2000
    s_nop 0
    buffer_load_dwordx4 v129, s[36:39], s53 offen lds
    s_add_u32 m0, s64, 0x3000
    s_nop 0
    buffer_load_dwordx4 v130, s[36:39], s53 offen lds
    s_add_u32 m0, s64, 0x4000
    s_nop 0
    buffer_load_dwordx4 v131, s[36:39], s53 offen lds
    s_add_u32 m0, s64, 0x5000
    s_nop 0
    buffer_load_dwordx4 v128, s[36:39], s54 offen lds
    s_add_u32 m0, s64, 0x6000
    s_nop 0
    buffer_load_dwordx4 v129, s[36:39], s54 offen lds
    s_add_u32 m0, s64, 0x7000
    s_nop 0
    buffer_load_dwordx4 v130, s[36:39], s54 offen lds
    s_add_u32 m0, s64, 0x8000
    s_nop 0
    buffer_load_dwordx4 v131, s[36:39], s54 offen lds
    v_mov_b32 v3, 0
    s_mov_b64 exec, 1
    buffer_atomic_umax v3, off, s[48:51], s59 sc0
    s_mov_b64 exec, -1
    v_add_u32 v136, 0, v21
    v_add_u32 v137, 14336, v21
    v_add_u32 v138, 28672, v21
    v_add_u32 v139, 43008, v21
    v_add_u32 v140, 57344, v21
    v_add_u32 v141, 71680, v21
    v_add_u32 v142, 86016, v21
    v_add_u32 v143, 100352, v21
    v_add_u32 v144, 4096, v1
    s_lshl2_add_u32 s3, s60, s22
    s_lshl1_add_u32 s3, s3, s68
    s_mul_i32 s3, s3, 57344
    s_add_u32 s4, s3, 5636096
    s_lshl1_add_u32 s3, s62, s65
    s_lshl_b32 s3, s3, 9
    s_add_u32 s3, s3, s69
    s_add_u32 s20, s3, 2048
    s_lshl1_add_u32 s3, s22, s68
    s_lshl_b32 s3, s3, 9
    s_add_u32 s3, s3, s69
    s_add_u32 s21, s3, 2048
    s_mul_i32 s24, s70, 114688
    s_lshl_b32 s3, s70, 13
    s_add_u32 s0, s3, s4
    s_mul_i32 s25, s71, 114688
    s_lshl_b32 s3, s71, 13
    s_add_u32 s1, s3, s4
    s_mul_i32 s26, s72, 114688
    s_lshl_b32 s3, s72, 13
    s_add_u32 s16, s3, s4
    s_mul_i32 s27, s73, 114688
    s_lshl_b32 s3, s73, 13
    s_add_u32 s17, s3, s4
    s_mul_i32 s32, s74, 114688
    s_lshl_b32 s3, s74, 13
    s_add_u32 s19, s3, s4
    s_mul_i32 s33, s75, 114688
    s_lshl_b32 s3, s75, 13
    s_add_u32 s23, s3, s4
    s_mul_i32 s34, s76, 114688
    s_lshl_b32 s3, s76, 13
    s_add_u32 s55, s3, s4
    v_accvgpr_write_b32 a168, 0
    v_accvgpr_write_b32 a169, 0
    s_lshl_b32 s9, s70, 12
    s_add_u32 s9, s9, s8
    s_waitcnt vmcnt(0)
    v_readfirstlane_b32 s3, v3
    s_nop 0
    s_cmp_ge_u32 s3, 7
    s_cbranch_scc1 L_ok3
    s_mov_b32 s58, 100000
L_spin3:
    s_mov_b64 exec, 1
    buffer_atomic_umax v3, off, s[48:51], s59 sc0
    s_mov_b64 exec, -1
    s_waitcnt vmcnt(0)
    v_readfirstlane_b32 s3, v3
    s_nop 0
    s_cmp_ge_u32 s3, 7
    s_cbranch_scc1 L_ok3
    s_sub_u32 s58, s58, 1
    s_cmp_lg_u32 s58, 0
    s_cbranch_scc1 L_spin3
L_ok3:
    buffer_load_dwordx4 a[40:43], v1, s[48:51], s9 offen sc1
    buffer_load_dwordx4 a[44:47], v1, s[48:51], s9 offen offset:1024 sc1
    buffer_load_dwordx4 a[48:51], v1, s[48:51], s9 offen offset:2048 sc1
    buffer_load_dwordx4 a[52:55], v1, s[48:51], s9 offen offset:3072 sc1
    s_lshl_b32 s9, s71, 12
    s_add_u32 s9, s9, s8
    buffer_load_dwordx4 a[56:59], v1, s[48:51], s9 offen sc1
    buffer_load_dwordx4 a[60:63], v1, s[48:51], s9 offen offset:1024 sc1
    buffer_load_dwordx4 a[64:67], v1, s[48:51], s9 offen offset:2048 sc1
    buffer_load_dwordx4 a[68:71], v1, s[48:51], s9 offen offset:3072 sc1
    s_lshl_b32 s9, s72, 12
    s_add_u32 s9, s9, s8
    buffer_load_dwordx4 a[72:75], v1, s[48:51], s9 offen sc1
    buffer_load_dwordx4 a[76:79], v1, s[48:51], s9 offen offset:1024 sc1
    s_barrier
    v_add_u32 v9, 61440, v9
    ds_read_b64_tr_b16 a[0:1], v9 offset:53248
    ds_read_b64_tr_b16 a[2:3], v9 offset:54272
    v_add_u32 v10, 61440, v10
    ds_read_b64_tr_b16 a[4:5], v10 offset:53248
    ds_read_b64_tr_b16 a[6:7], v10 offset:54272
    ds_read_b64_tr_b16 a[8:9], v9 offset:57344
    ds_read_b64_tr_b16 a[10:11], v9 offset:58368
    ds_read_b64_tr_b16 a[12:13], v10 offset:57344
    ds_read_b64_tr_b16 a[14:15], v10 offset:58368
    v_add_u32 v9, 61440, v9
    ds_read_b64_tr_b16 a[16:17], v9 offset:0
    ds_read_b64_tr_b16 a[18:19], v9 offset:1024
    v_add_u32 v10, 61440, v10
    ds_read_b64_tr_b16 a[20:21], v10 offset:0
    ds_read_b64_tr_b16 a[22:23], v10 offset:1024
    ds_read_b64_tr_b16 a[24:25], v9 offset:4096
    ds_read_b64_tr_b16 a[26:27], v9 offset:5120
    s_waitcnt vmcnt(9) lgkmcnt(6)
    v_mfma_f32_32x32x16_bf16 v[64:79], a[0:3], a[40:43], 0
    ds_read_b64_tr_b16 a[28:29], v10 offset:4096
    ds_read_b64_tr_b16 a[30:31], v10 offset:5120
    buffer_load_dwordx4 a[80:83], v1, s[48:51], s9 offen offset:2048 sc1
    v_mfma_f32_32x32x16_bf16 v[80:95], a[4:7], a[40:43], 0
    ds_read_b64_tr_b16 a[0:1], v9 offset:8192
    ds_read_b64_tr_b16 a[2:3], v9 offset:9216
    buffer_load_dwordx2 v[156:157], v30, s[48:51], s10 offen offset:0 sc1
    s_waitcnt vmcnt(10)
    v_mfma_f32_32x32x16_bf16 v[64:79], a[8:11], a[44:47], v[64:79]
    ds_read_b64_tr_b16 a[4:5], v10 offset:8192
    ds_read_b64_tr_b16 a[6:7], v10 offset:9216
    buffer_load_dwordx4 a[84:87], v1, s[48:51], s9 offen offset:3072 sc1
    v_accvgpr_read_b32 v28, a32
    v_mfma_f32_32x32x16_bf16 v[80:95], a[12:15], a[44:47], v[80:95]
    ds_read_b64_tr_b16 a[8:9], v9 offset:12288
    ds_read_b64_tr_b16 a[10:11], v9 offset:13312
    buffer_load_dwordx2 v[158:159], v30, s[48:51], s10 offen offset:256 sc1
    v_lshlrev_b32 v96, 16, v28
    s_waitcnt vmcnt(11) lgkmcnt(6)
    v_mfma_f32_32x32x16_bf16 v[64:79], a[16:19], a[48:51], v[64:79]
    ds_read_b64_tr_b16 a[12:13], v10 offset:12288
    ds_read_b64_tr_b16 a[14:15], v10 offset:13312
    s_lshl_b32 s9, s73, 12
    s_add_u32 s9, s9, s8
    buffer_load_dwordx4 a[88:91], v1, s[48:51], s9 offen sc1
    v_and_b32 v97, 0xffff0000, v28
    v_mfma_f32_32x32x16_bf16 v[80:95], a[20:23], a[48:51], v[80:95]
    ds_read_b64_tr_b16 a[16:17], v9 offset:16384
    ds_read_b64_tr_b16 a[18:19], v9 offset:17408
    buffer_load_dwordx2 v[160:161], v30, s[48:51], s10 offen offset:512 sc1
    v_accvgpr_read_b32 v28, a33
    s_waitcnt vmcnt(12)
    v_mfma_f32_32x32x16_bf16 v[64:79], a[24:27], a[52:55], v[64:79]
    ds_read_b64_tr_b16 a[20:21], v10 offset:16384
    ds_read_b64_tr_b16 a[22:23], v10 offset:17408
    buffer_load_dwordx4 a[92:95], v1, s[48:51], s9 offen offset:1024 sc1
    v_lshlrev_b32 v98, 16, v28
    v_mfma_f32_32x32x16_bf16 v[80:95], a[28:31], a[52:55], v[80:95]
    ds_read_b64_tr_b16 a[24:25], v9 offset:20480
    ds_read_b64_tr_b16 a[26:27], v9 offset:21504
    buffer_load_dwordx2 v[162:163], v30, s[48:51], s10 offen offset:768 sc1
    v_and_b32 v99, 0xffff0000, v28
    s_waitcnt vmcnt(13) lgkmcnt(6)
    v_mfma_f32_32x32x16_bf16 v[64:79], a[0:3], a[56:59], v[64:79]
    ds_read_b64_tr_b16 a[28:29], v10 offset:20480
    ds_read_b64_tr_b16 a[30:31], v10 offset:21504
    buffer_load_dwordx4 a[96:99], v1, s[48:51], s9 offen offset:2048 sc1
    v_accvgpr_read_b32 v28, a34
    v_mfma_f32_32x32x16_bf16 v[80:95], a[4:7], a[56:59], v[80:95]
    ds_read_b64_tr_b16 a[0:1], v9 offset:24576
    ds_read_b64_tr_b16 a[2:3], v9 offset:25600
    buffer_load_dwordx2 v[164:165], v30, s[48:51], s10 offen offset:1024 sc1
    v_lshlrev_b32 v100, 16, v28
    s_waitcnt vmcnt(14)
    v_mfma_f32_32x32x16_bf16 v[64:79], a[8:11], a[60:63], v[64:79]
    ds_read_b64_tr_b16 a[4:5], v10 offset:24576
    ds_read_b64_tr_b16 a[6:7], v10 offset:25600
    buffer_load_dwordx4 a[100:103], v1, s[48:51], s9 offen offset:3072 sc1
    v_and_b32 v101, 0xffff0000, v28
    v_mfma_f32_32x32x16_bf16 v[80:95], a[12:15], a[60:63], v[80:95]
    ds_read_b64_tr_b16 a[8:9], v9 offset:28672
    ds_read_b64_tr_b16 a[10:11], v9 offset:29696
    buffer_load_dwordx2 v[166:167], v30, s[48:51], s10 offen offset:1280 sc1
    v_accvgpr_read_b32 v28, a35
    s_waitcnt vmcnt(15) lgkmcnt(6)
    v_mfma_f32_32x32x16_bf16 v[64:79], a[16:19], a[64:67], v[64:79]
    ds_read_b64_tr_b16 a[12:13], v10 offset:28672
    ds_read_b64_tr_b16 a[14:15], v10 offset:29696
    s_lshl_b32 s9, s74, 12
    s_add_u32 s9, s9, s8
    buffer_load_dwordx4 a[104:107], v1, s[48:51], s9 offen sc1
    v_lshlrev_b32 v102, 16, v28
    v_mfma_f32_32x32x16_bf16 v[80:95], a[20:23], a[64:67], v[80:95]
    ds_read_b64_tr_b16 a[16:17], v9 offset:32768
    ds_read_b64_tr_b16 a[18:19], v9 offset:33792
    buffer_load_dwordx2 v[168:169], v30, s[48:51], s10 offen offset:1536 sc1
    v_and_b32 v103, 0xffff0000, v28
    s_waitcnt vmcnt(16)
    v_mfma_f32_32x32x16_bf16 v[64:79], a[24:27], a[68:71], v[64:79]
    ds_read_b64_tr_b16 a[20:21], v10 offset:32768
    ds_read_b64_tr_b16 a[22:23], v10 offset:33792
    buffer_load_dwordx4 a[108:111], v1, s[48:51], s9 offen offset:1024 sc1
    v_accvgpr_read_b32 v28, a36
    v_mfma_f32_32x32x16_bf16 v[80:95], a[28:31], a[68:71], v[80:95]
    ds_read_b64_tr_b16 a[24:25], v9 offset:36864
    ds_read_b64_tr_b16 a[26:27], v9 offset:37888
    v_lshlrev_b32 v104, 16, v28
    s_waitcnt vmcnt(16) lgkmcnt(6)
    v_mfma_f32_32x32x16_bf16 v[64:79], a[0:3], a[72:75], v[64:79]
    ds_read_b64_tr_b16 a[28:29], v10 offset:36864
    ds_read_b64_tr_b16 a[30:31], v10 offset:37888
    buffer_load_dwordx4 a[112:115], v1, s[48:51], s9 offen offset:2048 sc1
    v_and_b32 v105, 0xffff0000, v28
    v_mfma_f32_32x32x16_bf16 v[80:95], a[4:7], a[72:75], v[80:95]
    v_subrev_u32 v9, 122880, v9
    ds_read_b64_tr_b16 a[0:1], v9 offset:57344
    ds_read_b64_tr_b16 a[2:3], v9 offset:58368
    v_accvgpr_read_b32 v28, a37
    s_waitcnt vmcnt(16)
    v_mfma_f32_32x32x16_bf16 v[64:79], a[8:11], a[76:79], v[64:79]
    v_subrev_u32 v10, 122880, v10
    ds_read_b64_tr_b16 a[4:5], v10 offset:57344
    ds_read_b64_tr_b16 a[6:7], v10 offset:58368
    buffer_load_dwordx4 a[116:119], v1, s[48:51], s9 offen offset:3072 sc1
    v_lshlrev_b32 v106, 16, v28
    v_mfma_f32_32x32x16_bf16 v[80:95], a[12:15], a[76:79], v[80:95]
    v_add_u32 v9, 61440, v9
    ds_read_b64_tr_b16 a[8:9], v9 offset:0
    ds_read_b64_tr_b16 a[10:11], v9 offset:1024
    v_and_b32 v107, 0xffff0000, v28
    s_waitcnt vmcnt(16) lgkmcnt(6)
    v_mfma_f32_32x32x16_bf16 v[64:79], a[16:19], a[80:83], v[64:79]
    v_add_u32 v10, 61440, v10
    ds_read_b64_tr_b16 a[12:13], v10 offset:0
    ds_read_b64_tr_b16 a[14:15], v10 offset:1024
    s_lshl_b32 s9, s75, 12
    s_add_u32 s9, s9, s8
    buffer_load_dwordx4 a[120:123], v1, s[48:51], s9 offen sc1
    v_accvgpr_read_b32 v28, a38
    v_mfma_f32_32x32x16_bf16 v[80:95], a[20:23], a[80:83], v[80:95]
    ds_read_b64_tr_b16 a[16:17], v9 offset:4096
    ds_read_b64_tr_b16 a[18:19], v9 offset:5120
    v_lshlrev_b32 v108, 16, v28
    s_waitcnt vmcnt(15)
    v_mfma_f32_32x32x16_bf16 v[64:79], a[24:27], a[84:87], v[64:79]
    ds_read_b64_tr_b16 a[20:21], v10 offset:4096
    ds_read_b64_tr_b16 a[22:23], v10 offset:5120
    buffer_load_dwordx4 a[124:127], v1, s[48:51], s9 offen offset:1024 sc1
    v_and_b32 v109, 0xffff0000, v28
    v_mfma_f32_32x32x16_bf16 v[80:95], a[28:31], a[84:87], v[80:95]
    ds_read_b64_tr_b16 a[24:25], v9 offset:8192
    ds_read_b64_tr_b16 a[26:27], v9 offset:9216
    v_accvgpr_read_b32 v28, a39
    s_waitcnt vmcnt(14) lgkmcnt(6)
    v_mfma_f32_32x32x16_bf16 v[64:79], a[0:3], a[88:91], v[64:79]
    ds_read_b64_tr_b16 a[28:29], v10 offset:8192
    ds_read_b64_tr_b16 a[30:31], v10 offset:9216
    buffer_load_dwordx4 a[128:131], v1, s[48:51], s9 offen offset:2048 sc1
    v_lshlrev_b32 v110, 16, v28
    v_mfma_f32_32x32x16_bf16 v[80:95], a[4:7], a[88:91], v[80:95]
    ds_read_b64_tr_b16 a[0:1], v9 offset:12288
    ds_read_b64_tr_b16 a[2:3], v9 offset:13312
    v_and_b32 v111, 0xffff0000, v28
    s_waitcnt vmcnt(13)
    v_mfma_f32_32x32x16_bf16 v[64:79], a[8:11], a[92:95], v[64:79]
    ds_read_b64_tr_b16 a[4:5], v10 offset:12288
    ds_read_b64_tr_b16 a[6:7], v10 offset:13312
    buffer_load_dwordx4 a[132:135], v1, s[48:51], s9 offen offset:3072 sc1
    v_mfma_f32_32x32x16_bf16 v[80:95], a[12:15], a[92:95], v[80:95]
    ds_read_b64_tr_b16 a[8:9], v9 offset:16384
    ds_read_b64_tr_b16 a[10:11], v9 offset:17408
    s_waitcnt vmcnt(12) lgkmcnt(6)
    v_mfma_f32_32x32x16_bf16 v[64:79], a[16:19], a[96:99], v[64:79]
    ds_read_b64_tr_b16 a[12:13], v10 offset:16384
    ds_read_b64_tr_b16 a[14:15], v10 offset:17408
    s_lshl_b32 s9, s76, 12
    s_add_u32 s9, s9, s8
    buffer_load_dwordx4 a[136:139], v1, s[48:51], s9 offen sc1
    v_mfma_f32_32x32x16_bf16 v[80:95], a[20:23], a[96:99], v[80:95]
    ds_read_b64_tr_b16 a[16:17], v9 offset:20480
    ds_read_b64_tr_b16 a[18:19], v9 offset:21504
    s_waitcnt vmcnt(11)
    v_mfma_f32_32x32x16_bf16 v[64:79], a[24:27], a[100:103], v[64:79]
    ds_read_b64_tr_b16 a[20:21], v10 offset:20480
    ds_read_b64_tr_b16 a[22:23], v10 offset:21504
    buffer_load_dwordx4 a[140:143], v1, s[48:51], s9 offen offset:1024 sc1
    v_mfma_f32_32x32x16_bf16 v[80:95], a[28:31], a[100:103], v[80:95]
    v_subrev_u32 v9, 61440, v9
    ds_read_b64_tr_b16 a[24:25], v9 offset:0
    ds_read_b64_tr_b16 a[26:27], v9 offset:1024
    s_waitcnt vmcnt(10) lgkmcnt(6)
    v_mfma_f32_32x32x16_bf16 v[64:79], a[0:3], a[104:107], v[64:79]
    v_subrev_u32 v10, 61440, v10
    ds_read_b64_tr_b16 a[28:29], v10 offset:0
    ds_read_b64_tr_b16 a[30:31], v10 offset:1024
    buffer_load_dwordx4 a[144:147], v1, s[48:51], s9 offen offset:2048 sc1
    v_mfma_f32_32x32x16_bf16 v[80:95], a[4:7], a[104:107], v[80:95]
    ds_read_b64_tr_b16 a[0:1], v9 offset:4096
    ds_read_b64_tr_b16 a[2:3], v9 offset:5120
    v_mov_b32 v3, 0
    s_mov_b64 exec, 1
    buffer_atomic_umax v3, off, s[48:51], s7 sc0
    s_mov_b64 exec, -1
    s_waitcnt vmcnt(10)
    v_mfma_f32_32x32x16_bf16 v[64:79], a[8:11], a[108:111], v[64:79]
    ds_read_b64_tr_b16 a[4:5], v10 offset:4096
    ds_read_b64_tr_b16 a[6:7], v10 offset:5120
    buffer_load_dwordx4 a[148:151], v1, s[48:51], s9 offen offset:3072 sc1
    v_mfma_f32_32x32x16_bf16 v[80:95], a[12:15], a[108:111], v[80:95]
    ds_read_b64_tr_b16 a[8:9], v9 offset:8192
    ds_read_b64_tr_b16 a[10:11], v9 offset:9216
    s_waitcnt vmcnt(10) lgkmcnt(6)
    v_mfma_f32_32x32x16_bf16 v[64:79], a[16:19], a[112:115], v[64:79]
    ds_read_b64_tr_b16 a[12:13], v10 offset:8192
    ds_read_b64_tr_b16 a[14:15], v10 offset:9216
    v_mfma_f32_32x32x16_bf16 v[80:95], a[20:23], a[112:115], v[80:95]
    s_add_u32 m0, s64, 0x9000
    ds_read_b64_tr_b16 a[16:17], v9 offset:12288
    ds_read_b64_tr_b16 a[18:19], v9 offset:13312
    buffer_load_dwordx4 v132, s[36:39], s28 offen lds
    s_waitcnt vmcnt(10)
    v_mfma_f32_32x32x16_bf16 v[64:79], a[24:27], a[116:119], v[64:79]
    ds_read_b64_tr_b16 a[20:21], v10 offset:12288
    ds_read_b64_tr_b16 a[22:23], v10 offset:13312
    v_mfma_f32_32x32x16_bf16 v[80:95], a[28:31], a[116:119], v[80:95]
    s_add_u32 m0, s64, 0xa000
    ds_read_b64_tr_b16 a[24:25], v9 offset:16384
    ds_read_b64_tr_b16 a[26:27], v9 offset:17408
    buffer_load_dwordx4 v133, s[36:39], s28 offen lds
    s_waitcnt vmcnt(10) lgkmcnt(6)
    v_mfma_f32_32x32x16_bf16 v[64:79], a[0:3], a[120:123], v[64:79]
    ds_read_b64_tr_b16 a[28:29], v10 offset:16384
    ds_read_b64_tr_b16 a[30:31], v10 offset:17408
    v_mfma_f32_32x32x16_bf16 v[80:95], a[4:7], a[120:123], v[80:95]
    s_add_u32 m0, s64, 0xb000
    ds_read_b64_tr_b16 a[0:1], v9 offset:20480
    ds_read_b64_tr_b16 a[2:3], v9 offset:21504
    buffer_load_dwordx4 v134, s[36:39], s28 offen lds
    s_waitcnt vmcnt(10)
    v_mfma_f32_32x32x16_bf16 v[64:79], a[8:11], a[124:127], v[64:79]
    ds_read_b64_tr_b16 a[4:5], v10 offset:20480
    ds_read_b64_tr_b16 a[6:7], v10 offset:21504
    v_mfma_f32_32x32x16_bf16 v[80:95], a[12:15], a[124:127], v[80:95]
    s_add_u32 m0, s64, 0xc000
    ds_read_b64_tr_b16 a[8:9], v9 offset:24576
    ds_read_b64_tr_b16 a[10:11], v9 offset:25600
    buffer_load_dwordx4 v135, s[36:39], s28 offen lds
    s_waitcnt vmcnt(10) lgkmcnt(6)
    v_mfma_f32_32x32x16_bf16 v[64:79], a[16:19], a[128:131], v[64:79]
    ds_read_b64_tr_b16 a[12:13], v10 offset:24576
    ds_read_b64_tr_b16 a[14:15], v10 offset:25600
    v_mfma_f32_32x32x16_bf16 v[80:95], a[20:23], a[128:131], v[80:95]
    s_add_u32 m0, s64, 0xd000
    ds_read_b64_tr_b16 a[16:17], v9 offset:28672
    ds_read_b64_tr_b16 a[18:19], v9 offset:29696
    buffer_load_dwordx4 v132, s[36:39], s29 offen lds
    s_waitcnt vmcnt(10)
    v_mfma_f32_32x32x16_bf16 v[64:79], a[24:27], a[132:135], v[64:79]
    ds_read_b64_tr_b16 a[20:21], v10 offset:28672
    ds_read_b64_tr_b16 a[22:23], v10 offset:29696
    v_mfma_f32_32x32x16_bf16 v[80:95], a[28:31], a[132:135], v[80:95]
    s_add_u32 m0, s64, 0x15000
    ds_read_b64_tr_b16 a[24:25], v9 offset:32768
    ds_read_b64_tr_b16 a[26:27], v9 offset:33792
    buffer_load_dwordx4 v133, s[36:39], s29 offen lds
    s_waitcnt vmcnt(10) lgkmcnt(6)
    v_mfma_f32_32x32x16_bf16 v[64:79], a[0:3], a[136:139], v[64:79]
    ds_read_b64_tr_b16 a[28:29], v10 offset:32768
    ds_read_b64_tr_b16 a[30:31], v10 offset:33792
    v_mfma_f32_32x32x16_bf16 v[80:95], a[4:7], a[136:139], v[80:95]
    s_add_u32 m0, s64, 0x16000
    v_add_u32 v11, 61440, v11
    ds_read_b64_tr_b16 a[0:1], v11 offset:53248
    ds_read_b64_tr_b16 a[2:3], v11 offset:54272
    buffer_load_dwordx4 v134, s[36:39], s29 offen lds
    v_add_f32 v156, v156, v158
    v_add_f32 v157, v157, v159
    s_waitcnt vmcnt(10)
    v_mfma_f32_32x32x16_bf16 v[64:79], a[8:11], a[140:143], v[64:79]
    v_add_u32 v12, 61440, v12
    ds_read_b64_tr_b16 a[4:5], v12 offset:53248
    ds_read_b64_tr_b16 a[6:7], v12 offset:54272
    v_add_f32 v160, v160, v162
    v_add_f32 v161, v161, v163
    v_mfma_f32_32x32x16_bf16 v[80:95], a[12:15], a[140:143], v[80:95]
    s_add_u32 m0, s64, 0x17000
    ds_read_b64_tr_b16 a[8:9], v11 offset:57344
    ds_read_b64_tr_b16 a[10:11], v11 offset:58368
    buffer_load_dwordx4 v135, s[36:39], s29 offen lds
    v_add_f32 v164, v164, v166
    v_add_f32 v165, v165, v167
    s_waitcnt vmcnt(10) lgkmcnt(6)
    v_mfma_f32_32x32x16_bf16 v[64:79], a[16:19], a[144:147], v[64:79]
    ds_read_b64_tr_b16 a[12:13], v12 offset:57344
    ds_read_b64_tr_b16 a[14:15], v12 offset:58368
    v_add_f32 v156, v156, v160
    v_add_f32 v157, v157, v161
    v_mfma_f32_32x32x16_bf16 v[80:95], a[20:23], a[144:147], v[80:95]
    s_add_u32 m0, s64, 0x18000
    v_add_u32 v11, 61440, v11
    ds_read_b64_tr_b16 a[16:17], v11 offset:0
    ds_read_b64_tr_b16 a[18:19], v11 offset:1024
    buffer_load_dwordx4 v132, s[36:39], s30 offen lds
    v_add_f32 v164, v164, v168
    v_add_f32 v165, v165, v169
    s_waitcnt vmcnt(9)
    v_mfma_f32_32x32x16_bf16 v[64:79], a[24:27], a[148:151], v[64:79]
    v_add_u32 v12, 61440, v12
    ds_read_b64_tr_b16 a[20:21], v12 offset:0
    ds_read_b64_tr_b16 a[22:23], v12 offset:1024
    v_add_f32 v156, v156, v164
    v_add_f32 v157, v157, v165
    v_mfma_f32_32x32x16_bf16 v[80:95], a[28:31], a[148:151], v[80:95]
    s_add_u32 m0, s64, 0x19000
    ds_read_b64_tr_b16 a[24:25], v11 offset:4096
    ds_read_b64_tr_b16 a[26:27], v11 offset:5120
    buffer_load_dwordx4 v133, s[36:39], s30 offen lds
    v_mov_b32 v28, v156
    s_nop 1
    v_permlane32_swap_b32 v28, v156
    s_waitcnt lgkmcnt(6)
    v_mfma_f32_32x32x16_bf16 v[32:47], a[0:3], a[40:43], 0
    ds_read_b64_tr_b16 a[28:29], v12 offset:4096
    ds_read_b64_tr_b16 a[30:31], v12 offset:5120
    v_add_f32 v156, v28, v156
    v_mov_b32 v28, v157
    v_mfma_f32_32x32x16_bf16 v[48:63], a[4:7], a[40:43], 0
    s_add_u32 m0, s64, 0x1a000
    ds_read_b64_tr_b16 a[0:1], v11 offset:8192
    ds_read_b64_tr_b16 a[2:3], v11 offset:9216
    buffer_load_dwordx4 v134, s[36:39], s30 offen lds
    v_readfirstlane_b32 s3, v3
    s_nop 0
    s_cmp_ge_u32 s3, 4
    s_cbranch_scc1 L_ok4
    s_mov_b32 s58, 100000
L_spin4:
    s_mov_b64 exec, 1
    buffer_atomic_umax v3, off, s[48:51], s7 sc0
    s_mov_b64 exec, -1
    s_waitcnt vmcnt(0)
    v_readfirstlane_b32 s3, v3
    s_nop 0
    s_cmp_ge_u32 s3, 4
    s_cbranch_scc1 L_ok4
    s_sub_u32 s58, s58, 1
    s_cmp_lg_u32 s58, 0
    s_cbranch_scc1 L_spin4
L_ok4:
    s_lshl_b32 s3, s66, 11
    s_add_u32 s3, s3, 655360
    buffer_load_dwordx4 a[152:155], v4, s[48:51], s3 offen offset:0 sc1
    buffer_load_dwordx4 a[156:159], v4, s[48:51], s3 offen offset:512 sc1
    buffer_load_dwordx4 a[160:163], v4, s[48:51], s3 offen offset:1024 sc1
    buffer_load_dwordx4 a[164:167], v4, s[48:51], s3 offen offset:1536 sc1
    v_permlane32_swap_b32 v28, v157
    v_add_f32 v157, v28, v157
    v_mfma_f32_32x32x16_bf16 v[32:47], a[8:11], a[44:47], v[32:47]
    ds_read_b64_tr_b16 a[4:5], v12 offset:8192
    ds_read_b64_tr_b16 a[6:7], v12 offset:9216
    v_mul_f32 v246, 0x3b124925, v156
    v_mul_f32 v154, 0x3b124925, v157
    v_mfma_f32_32x32x16_bf16 v[48:63], a[12:15], a[44:47], v[48:63]
    s_add_u32 m0, s64, 0x1b000
    ds_read_b64_tr_b16 a[8:9], v11 offset:12288
    ds_read_b64_tr_b16 a[10:11], v11 offset:13312
    buffer_load_dwordx4 v135, s[36:39], s30 offen lds
    v_fma_f32 v154, -v246, v246, v154
    v_max_f32 v154, 0, v154
    s_waitcnt lgkmcnt(6)
    v_mfma_f32_32x32x16_bf16 v[32:47], a[16:19], a[48:51], v[32:47]
    ds_read_b64_tr_b16 a[12:13], v12 offset:12288
    ds_read_b64_tr_b16 a[14:15], v12 offset:13312
    v_cvt_pk_bf16_f32 v246, v246, v154
    v_and_b32 v154, 0xffff0000, v246
    v_mfma_f32_32x32x16_bf16 v[48:63], a[20:23], a[48:51], v[48:63]
    ds_read_b64_tr_b16 a[16:17], v11 offset:16384
    ds_read_b64_tr_b16 a[18:19], v11 offset:17408
    v_lshlrev_b32 v246, 16, v246
    v_add_f32 v154, 0x3727c5ac, v154
    v_mfma_f32_32x32x16_bf16 v[32:47], a[24:27], a[52:55], v[32:47]
    ds_read_b64_tr_b16 a[20:21], v12 offset:16384
    ds_read_b64_tr_b16 a[22:23], v12 offset:17408
    v_cvt_pk_bf16_f32 v154, v154, v154
    v_lshlrev_b32 v154, 16, v154
    v_mfma_f32_32x32x16_bf16 v[48:63], a[28:31], a[52:55], v[48:63]
    s_barrier
    ds_read_b64_tr_b16 a[24:25], v11 offset:20480
    ds_read_b64_tr_b16 a[26:27], v11 offset:21504
    v_sqrt_f32 v154, v154
    s_nop 0
    v_cvt_pk_bf16_f32 v154, v154, v154
    s_waitcnt lgkmcnt(6)
    v_mfma_f32_32x32x16_bf16 v[32:47], a[0:3], a[56:59], v[32:47]
    s_add_u32 m0, s64, 0x1c000
    ds_read_b64_tr_b16 a[28:29], v12 offset:20480
    ds_read_b64_tr_b16 a[30:31], v12 offset:21504
    buffer_load_dwordx4 v132, s[36:39], s31 offen lds
    v_lshlrev_b32 v154, 16, v154
    v_rcp_f32 v252, v154
    v_mfma_f32_32x32x16_bf16 v[48:63], a[4:7], a[56:59], v[48:63]
    ds_read_b64_tr_b16 a[0:1], v11 offset:24576
    ds_read_b64_tr_b16 a[2:3], v11 offset:25600
    v_mul_f32 v152, 0xbfb8aa3b, v252
    v_cvt_pk_bf16_f32 v148, -v246, -v246
    v_mfma_f32_32x32x16_bf16 v[32:47], a[8:11], a[60:63], v[32:47]
    s_add_u32 m0, s64, 0x1d000
    ds_read_b64_tr_b16 a[4:5], v12 offset:24576
    ds_read_b64_tr_b16 a[6:7], v12 offset:25600
    buffer_load_dwordx4 v133, s[36:39], s31 offen lds
    v_mov_b32 v149, 0
    v_mov_b32 v150, 0
    v_mfma_f32_32x32x16_bf16 v[48:63], a[12:15], a[60:63], v[48:63]
    ds_read_b64_tr_b16 a[8:9], v11 offset:28672
    ds_read_b64_tr_b16 a[10:11], v11 offset:29696
    v_mov_b32 v151, 0
    v_cndmask_b32 v148, v148, 0, s[14:15]
    s_waitcnt lgkmcnt(6)
    v_mfma_f32_32x32x16_bf16 v[32:47], a[16:19], a[64:67], v[32:47]
    s_add_u32 m0, s64, 0x1e000
    ds_read_b64_tr_b16 a[12:13], v12 offset:28672
    ds_read_b64_tr_b16 a[14:15], v12 offset:29696
    buffer_load_dwordx4 v134, s[36:39], s31 offen lds
    v_mfma_f32_32x32x16_bf16 v[48:63], a[20:23], a[64:67], v[48:63]
    ds_read_b64_tr_b16 a[16:17], v11 offset:32768
    ds_read_b64_tr_b16 a[18:19], v11 offset:33792
    v_mfma_f32_32x32x16_bf16 v[32:47], a[24:27], a[68:71], v[32:47]
    s_add_u32 m0, s64, 0x1f000
    ds_read_b64_tr_b16 a[20:21], v12 offset:32768
    ds_read_b64_tr_b16 a[22:23], v12 offset:33792
    buffer_load_dwordx4 v135, s[36:39], s31 offen lds
    v_mfma_f32_32x32x16_bf16 v[48:63], a[28:31], a[68:71], v[48:63]
    s_barrier
    ds_read_b64_tr_b16 a[24:25], v11 offset:36864
    ds_read_b64_tr_b16 a[26:27], v11 offset:37888
    s_waitcnt vmcnt(8)
    v_mfma_f32_32x32x16_bf16 v[64:79], a[152:155], v[148:151], v[64:79]
    s_add_u32 m0, s64, 0x20000
    s_nop 0
    buffer_load_dwordx4 v132, s[36:39], s52 offen lds
    s_waitcnt vmcnt(8)
    v_mfma_f32_32x32x16_bf16 v[80:95], a[154:157], v[148:151], v[80:95]
    s_waitcnt lgkmcnt(6)
    v_mfma_f32_32x32x16_bf16 v[32:47], a[0:3], a[72:75], v[32:47]
    s_add_u32 m0, s64, 0x21000
    ds_read_b64_tr_b16 a[28:29], v12 offset:36864
    ds_read_b64_tr_b16 a[30:31], v12 offset:37888
    buffer_load_dwordx4 v133, s[36:39], s52 offen lds
    s_nop 0
    v_mul_f32 v240, v152, v64
    v_mfma_f32_32x32x16_bf16 v[48:63], a[4:7], a[72:75], v[48:63]
    v_subrev_u32 v11, 122880, v11
    ds_read_b64_tr_b16 a[0:1], v11 offset:57344
    ds_read_b64_tr_b16 a[2:3], v11 offset:58368
    v_exp_f32 v240, v240
    v_mfma_f32_32x32x16_bf16 v[32:47], a[8:11], a[76:79], v[32:47]
    s_add_u32 m0, s64, 0x22000
    v_subrev_u32 v12, 122880, v12
    ds_read_b64_tr_b16 a[4:5], v12 offset:57344
    ds_read_b64_tr_b16 a[6:7], v12 offset:58368
    buffer_load_dwordx4 v134, s[36:39], s52 offen lds
    v_fma_f32 v240, v240, v154, v154
    v_mul_f32 v241, v152, v65
    v_mfma_f32_32x32x16_bf16 v[48:63], a[12:15], a[76:79], v[48:63]
    v_add_u32 v11, 61440, v11
    ds_read_b64_tr_b16 a[8:9], v11 offset:0
    ds_read_b64_tr_b16 a[10:11], v11 offset:1024
    v_exp_f32 v241, v241
    s_waitcnt lgkmcnt(6)
    v_mfma_f32_32x32x16_bf16 v[32:47], a[16:19], a[80:83], v[32:47]
    s_add_u32 m0, s64, 0x23000
    v_add_u32 v12, 61440, v12
    ds_read_b64_tr_b16 a[12:13], v12 offset:0
    ds_read_b64_tr_b16 a[14:15], v12 offset:1024
    buffer_load_dwordx4 v135, s[36:39], s52 offen lds
    v_rcp_f32 v240, v240
    v_fma_f32 v241, v241, v154, v154
    v_mul_f32 v242, v152, v66
    v_mfma_f32_32x32x16_bf16 v[48:63], a[20:23], a[80:83], v[48:63]
    ds_read_b64_tr_b16 a[16:17], v11 offset:4096
    ds_read_b64_tr_b16 a[18:19], v11 offset:5120
    v_exp_f32 v242, v242
    v_mul_f32 v240, v240, v72
    v_mfma_f32_32x32x16_bf16 v[32:47], a[24:27], a[84:87], v[32:47]
    ds_read_b64_tr_b16 a[20:21], v12 offset:4096
    ds_read_b64_tr_b16 a[22:23], v12 offset:5120
    v_rcp_f32 v241, v241
    v_fma_f32 v242, v242, v154, v154
    v_mul_f32 v243, v152, v67
    v_mfma_f32_32x32x16_bf16 v[48:63], a[28:31], a[84:87], v[48:63]
    s_barrier
    ds_read_b64_tr_b16 a[24:25], v11 offset:8192
    ds_read_b64_tr_b16 a[26:27], v11 offset:9216
    v_exp_f32 v243, v243
    v_mul_f32 v241, v241, v73
    s_waitcnt lgkmcnt(6)
    v_mfma_f32_32x32x16_bf16 v[32:47], a[0:3], a[88:91], v[32:47]
    s_add_u32 m0, s64, 0x24000
    ds_read_b64_tr_b16 a[28:29], v12 offset:8192
    ds_read_b64_tr_b16 a[30:31], v12 offset:9216
    buffer_load_dwordx4 v132, s[36:39], s53 offen lds
    v_rcp_f32 v242, v242
    v_fma_f32 v243, v243, v154, v154
    v_mul_f32 v244, v152, v68
    v_mfma_f32_32x32x16_bf16 v[48:63], a[4:7], a[88:91], v[48:63]
    ds_read_b64_tr_b16 a[0:1], v11 offset:12288
    ds_read_b64_tr_b16 a[2:3], v11 offset:13312
    v_exp_f32 v244, v244
    v_cvt_pk_bf16_f32 v248, v240, v241
    v_mul_f32 v242, v242, v74
    v_mfma_f32_32x32x16_bf16 v[32:47], a[8:11], a[92:95], v[32:47]
    s_add_u32 m0, s64, 0x25000
    ds_read_b64_tr_b16 a[4:5], v12 offset:12288
    ds_read_b64_tr_b16 a[6:7], v12 offset:13312
    buffer_load_dwordx4 v133, s[36:39], s53 offen lds
    v_rcp_f32 v243, v243
    v_fma_f32 v244, v244, v154, v154
    v_mul_f32 v245, v152, v69
    v_mfma_f32_32x32x16_bf16 v[48:63], a[12:15], a[92:95], v[48:63]
    ds_read_b64_tr_b16 a[8:9], v11 offset:16384
    ds_read_b64_tr_b16 a[10:11], v11 offset:17408
    v_exp_f32 v245, v245
    v_mul_f32 v243, v243, v75
    s_waitcnt lgkmcnt(6)
    v_mfma_f32_32x32x16_bf16 v[32:47], a[16:19], a[96:99], v[32:47]
    s_add_u32 m0, s64, 0x26000
    ds_read_b64_tr_b16 a[12:13], v12 offset:16384
    ds_read_b64_tr_b16 a[14:15], v12 offset:17408
    buffer_load_dwordx4 v134, s[36:39], s53 offen lds
    v_rcp_f32 v244, v244
    v_fma_f32 v245, v245, v154, v154
    v_mul_f32 v240, v152, v70
    v_mfma_f32_32x32x16_bf16 v[48:63], a[20:23], a[96:99], v[48:63]
    ds_read_b64_tr_b16 a[16:17], v11 offset:20480
    ds_read_b64_tr_b16 a[18:19], v11 offset:21504
    v_exp_f32 v240, v240
    v_cvt_pk_bf16_f32 v249, v242, v243
    v_mul_f32 v244, v244, v76
    v_mfma_f32_32x32x16_bf16 v[32:47], a[24:27], a[100:103], v[32:47]
    s_add_u32 m0, s64, 0x27000
    ds_read_b64_tr_b16 a[20:21], v12 offset:20480
    ds_read_b64_tr_b16 a[22:23], v12 offset:21504
    buffer_load_dwordx4 v135, s[36:39], s53 offen lds
    v_rcp_f32 v245, v245
    v_fma_f32 v240, v240, v154, v154
    v_mul_f32 v241, v152, v71
    v_mfma_f32_32x32x16_bf16 v[48:63], a[28:31], a[100:103], v[48:63]
    s_barrier
    v_subrev_u32 v11, 61440, v11
    ds_read_b64_tr_b16 a[24:25], v11 offset:0
    ds_read_b64_tr_b16 a[26:27], v11 offset:1024
    v_exp_f32 v241, v241
    v_mul_f32 v245, v245, v77
    s_waitcnt lgkmcnt(6)
    v_mfma_f32_32x32x16_bf16 v[32:47], a[0:3], a[104:107], v[32:47]
    s_add_u32 m0, s64, 0xe000
    v_subrev_u32 v12, 61440, v12
    ds_read_b64_tr_b16 a[28:29], v12 offset:0
    ds_read_b64_tr_b16 a[30:31], v12 offset:1024
    buffer_load_dwordx4 v132, s[36:39], s54 offen lds
    v_rcp_f32 v240, v240
    v_fma_f32 v241, v241, v154, v154
    v_mul_f32 v242, v152, v80
    v_mfma_f32_32x32x16_bf16 v[48:63], a[4:7], a[104:107], v[48:63]
    ds_read_b64_tr_b16 a[0:1], v11 offset:4096
    ds_read_b64_tr_b16 a[2:3], v11 offset:5120
    v_exp_f32 v242, v242
    v_cvt_pk_bf16_f32 v250, v244, v245
    v_mul_f32 v240, v240, v78
    v_mfma_f32_32x32x16_bf16 v[32:47], a[8:11], a[108:111], v[32:47]
    s_add_u32 m0, s64, 0xf000
    ds_read_b64_tr_b16 a[4:5], v12 offset:4096
    ds_read_b64_tr_b16 a[6:7], v12 offset:5120
    buffer_load_dwordx4 v133, s[36:39], s54 offen lds
    v_rcp_f32 v241, v241
    v_fma_f32 v242, v242, v154, v154
    v_mul_f32 v243, v152, v81
    v_mfma_f32_32x32x16_bf16 v[48:63], a[12:15], a[108:111], v[48:63]
    ds_read_b64_tr_b16 a[8:9], v11 offset:8192
    ds_read_b64_tr_b16 a[10:11], v11 offset:9216
    v_exp_f32 v243, v243
    v_mul_f32 v241, v241, v79
    s_waitcnt lgkmcnt(6)
    v_mfma_f32_32x32x16_bf16 v[32:47], a[16:19], a[112:115], v[32:47]
    s_add_u32 m0, s64, 0x10000
    ds_read_b64_tr_b16 a[12:13], v12 offset:8192
    ds_read_b64_tr_b16 a[14:15], v12 offset:9216
    buffer_load_dwordx4 v134, s[36:39], s54 offen lds
    v_rcp_f32 v242, v242
    v_fma_f32 v243, v243, v154, v154
    v_mul_f32 v244, v152, v82
    v_mfma_f32_32x32x16_bf16 v[48:63], a[20:23], a[112:115], v[48:63]
    ds_read_b64_tr_b16 a[16:17], v11 offset:12288
    ds_read_b64_tr_b16 a[18:19], v11 offset:13312
    v_exp_f32 v244, v244
    v_cvt_pk_bf16_f32 v251, v240, v241
    v_mul_f32 v242, v242, v88
    v_mfma_f32_32x32x16_bf16 v[32:47], a[24:27], a[116:119], v[32:47]
    s_add_u32 m0, s64, 0x11000
    ds_read_b64_tr_b16 a[20:21], v12 offset:12288
    ds_read_b64_tr_b16 a[22:23], v12 offset:13312
    buffer_load_dwordx4 v135, s[36:39], s54 offen lds
    buffer_store_dwordx4 v[248:251], v1, s[48:51], s13 offen sc1
    v_rcp_f32 v243, v243
    v_fma_f32 v244, v244, v154, v154
    v_mul_f32 v245, v152, v83
    v_mfma_f32_32x32x16_bf16 v[48:63], a[28:31], a[116:119], v[48:63]
    s_barrier
    ds_read_b64_tr_b16 a[24:25], v11 offset:16384
    ds_read_b64_tr_b16 a[26:27], v11 offset:17408
    v_exp_f32 v245, v245
    v_mul_f32 v243, v243, v89
    s_waitcnt lgkmcnt(6)
    v_mfma_f32_32x32x16_bf16 v[32:47], a[0:3], a[120:123], v[32:47]
    s_add_u32 m0, s64, 0x12000
    ds_read_b64_tr_b16 a[28:29], v12 offset:16384
    ds_read_b64_tr_b16 a[30:31], v12 offset:17408
    buffer_load_dwordx4 v136, s[40:43], s24 offen lds
    v_rcp_f32 v244, v244
    v_fma_f32 v245, v245, v154, v154
    v_mul_f32 v240, v152, v84
    v_mfma_f32_32x32x16_bf16 v[48:63], a[4:7], a[120:123], v[48:63]
    ds_read_b64_tr_b16 a[0:1], v11 offset:20480
    ds_read_b64_tr_b16 a[2:3], v11 offset:21504
    v_exp_f32 v240, v240
    v_cvt_pk_bf16_f32 v252, v242, v243
    v_mul_f32 v244, v244, v90
    v_mfma_f32_32x32x16_bf16 v[32:47], a[8:11], a[124:127], v[32:47]
    s_add_u32 m0, s64, 0x13000
    ds_read_b64_tr_b16 a[4:5], v12 offset:20480
    ds_read_b64_tr_b16 a[6:7], v12 offset:21504
    buffer_load_dwordx4 v137, s[40:43], s24 offen lds
    v_rcp_f32 v245, v245
    v_fma_f32 v240, v240, v154, v154
    v_mul_f32 v241, v152, v85
    v_mfma_f32_32x32x16_bf16 v[48:63], a[12:15], a[124:127], v[48:63]
    ds_read_b64_tr_b16 a[8:9], v11 offset:24576
    ds_read_b64_tr_b16 a[10:11], v11 offset:25600
    v_exp_f32 v241, v241
    v_mul_f32 v245, v245, v91
    s_waitcnt lgkmcnt(6)
    v_mfma_f32_32x32x16_bf16 v[32:47], a[16:19], a[128:131], v[32:47]
    s_add_u32 m0, s64, 0x14000
    ds_read_b64_tr_b16 a[12:13], v12 offset:24576
    ds_read_b64_tr_b16 a[14:15], v12 offset:25600
    buffer_load_dwordx4 v136, s[40:43], s25 offen lds
    v_rcp_f32 v240, v240
    v_fma_f32 v241, v241, v154, v154
    v_mul_f32 v242, v152, v86
    v_mfma_f32_32x32x16_bf16 v[48:63], a[20:23], a[128:131], v[48:63]
    ds_read_b64_tr_b16 a[16:17], v11 offset:28672
    ds_read_b64_tr_b16 a[18:19], v11 offset:29696
    v_exp_f32 v242, v242
    v_cvt_pk_bf16_f32 v253, v244, v245
    v_mul_f32 v240, v240, v92
    v_mfma_f32_32x32x16_bf16 v[32:47], a[24:27], a[132:135], v[32:47]
    s_add_u32 m0, s64, 0x0
    ds_read_b64_tr_b16 a[20:21], v12 offset:28672
    ds_read_b64_tr_b16 a[22:23], v12 offset:29696
    buffer_load_dwordx4 v137, s[40:43], s25 offen lds
    v_rcp_f32 v241, v241
    v_fma_f32 v242, v242, v154, v154
    v_mul_f32 v243, v152, v87
    v_mfma_f32_32x32x16_bf16 v[48:63], a[28:31], a[132:135], v[48:63]
    s_barrier
    ds_read_b64_tr_b16 a[24:25], v11 offset:32768
    ds_read_b64_tr_b16 a[26:27], v11 offset:33792
    v_exp_f32 v243, v243
    v_mul_f32 v241, v241, v93
    s_waitcnt lgkmcnt(6)
    v_mfma_f32_32x32x16_bf16 v[32:47], a[0:3], a[136:139], v[32:47]
    s_add_u32 m0, s64, 0x1000
    ds_read_b64_tr_b16 a[28:29], v12 offset:32768
    ds_read_b64_tr_b16 a[30:31], v12 offset:33792
    buffer_load_dwordx4 v136, s[40:43], s26 offen lds
    v_rcp_f32 v242, v242
    v_fma_f32 v243, v243, v154, v154
    v_mfma_f32_32x32x16_bf16 v[48:63], a[4:7], a[136:139], v[48:63]
    s_barrier
    ds_read_b64_tr_b16 a[0:1], v9 offset:36864
    ds_read_b64_tr_b16 a[2:3], v9 offset:37888
    v_cvt_pk_bf16_f32 v254, v240, v241
    v_mul_f32 v242, v242, v94
    v_mfma_f32_32x32x16_bf16 v[32:47], a[8:11], a[140:143], v[32:47]
    s_add_u32 m0, s64, 0x2000
    ds_read_b64_tr_b16 a[4:5], v10 offset:36864
    ds_read_b64_tr_b16 a[6:7], v10 offset:37888
    buffer_load_dwordx4 v137, s[40:43], s26 offen lds
    v_rcp_f32 v243, v243
    v_mfma_f32_32x32x16_bf16 v[48:63], a[12:15], a[140:143], v[48:63]
    ds_read_b64_tr_b16 a[8:9], v9 offset:40960
    ds_read_b64_tr_b16 a[10:11], v9 offset:41984
    v_mul_f32 v243, v243, v95
    s_waitcnt lgkmcnt(6)
    v_mfma_f32_32x32x16_bf16 v[32:47], a[16:19], a[144:147], v[32:47]
    s_add_u32 m0, s64, 0x3000
    ds_read_b64_tr_b16 a[12:13], v10 offset:40960
    ds_read_b64_tr_b16 a[14:15], v10 offset:41984
    buffer_load_dwordx4 v136, s[40:43], s27 offen lds
    v_mfma_f32_32x32x16_bf16 v[48:63], a[20:23], a[144:147], v[48:63]
    ds_read_b64_tr_b16 a[16:17], v9 offset:45056
    ds_read_b64_tr_b16 a[18:19], v9 offset:46080
    v_cvt_pk_bf16_f32 v255, v242, v243
    v_mfma_f32_32x32x16_bf16 v[32:47], a[24:27], a[148:151], v[32:47]
    s_add_u32 m0, s64, 0x4000
    ds_read_b64_tr_b16 a[20:21], v10 offset:45056
    ds_read_b64_tr_b16 a[22:23], v10 offset:46080
    buffer_load_dwordx4 v137, s[40:43], s27 offen lds
    buffer_store_dwordx4 v[252:255], v1, s[48:51], s13 offen offset:1024 sc1
    v_mfma_f32_32x32x16_bf16 v[48:63], a[28:31], a[148:151], v[48:63]
    s_barrier
    ds_read_b64_tr_b16 a[24:25], v9 offset:49152
    ds_read_b64_tr_b16 a[26:27], v9 offset:50176
    v_mfma_f32_32x32x16_bf16 v[32:47], a[156:159], v[148:151], v[32:47]
    s_add_u32 m0, s64, 0x5000
    s_nop 0
    buffer_load_dwordx4 v136, s[40:43], s32 offen lds
    s_waitcnt vmcnt(29)
    v_mfma_f32_32x32x16_bf16 v[48:63], a[158:161], v[148:151], v[48:63]
    s_waitcnt lgkmcnt(6)
    v_mfma_f32_32x32x16_bf16 v[200:215], a[0:3], a[40:43], 0
    s_add_u32 m0, s64, 0x6000
    ds_read_b64_tr_b16 a[28:29], v10 offset:49152
    ds_read_b64_tr_b16 a[30:31], v10 offset:50176
    buffer_load_dwordx4 v137, s[40:43], s32 offen lds
    s_nop 0
    v_mul_f32 v240, v152, v32
    v_mfma_f32_32x32x16_bf16 v[216:231], a[4:7], a[40:43], 0
    ds_read_b64_tr_b16 a[0:1], v9 offset:53248
    ds_read_b64_tr_b16 a[2:3], v9 offset:54272
    v_exp_f32 v240, v240
    v_mfma_f32_32x32x16_bf16 v[200:215], a[8:11], a[44:47], v[200:215]
    s_add_u32 m0, s64, 0x7000
    ds_read_b64_tr_b16 a[4:5], v10 offset:53248
    ds_read_b64_tr_b16 a[6:7], v10 offset:54272
    buffer_load_dwordx4 v136, s[40:43], s33 offen lds
    v_fma_f32 v240, v240, v154, v154
    v_mul_f32 v241, v152, v33
    v_mfma_f32_32x32x16_bf16 v[216:231], a[12:15], a[44:47], v[216:231]
    v_add_u32 v9, 61440, v9
    ds_read_b64_tr_b16 a[8:9], v9 offset:24576
    ds_read_b64_tr_b16 a[10:11], v9 offset:25600
    v_exp_f32 v241, v241
    s_waitcnt lgkmcnt(6)
    v_mfma_f32_32x32x16_bf16 v[200:215], a[16:19], a[48:51], v[200:215]
    s_add_u32 m0, s64, 0x8000
    v_add_u32 v10, 61440, v10
    ds_read_b64_tr_b16 a[12:13], v10 offset:24576
    ds_read_b64_tr_b16 a[14:15], v10 offset:25600
    buffer_load_dwordx4 v137, s[40:43], s33 offen lds
    v_rcp_f32 v240, v240
    v_fma_f32 v241, v241, v154, v154
    v_mul_f32 v242, v152, v34
    v_mfma_f32_32x32x16_bf16 v[216:231], a[20:23], a[48:51], v[216:231]
    ds_read_b64_tr_b16 a[16:17], v9 offset:28672
    ds_read_b64_tr_b16 a[18:19], v9 offset:29696
    v_exp_f32 v242, v242
    v_mul_f32 v240, v240, v40
    v_mfma_f32_32x32x16_bf16 v[200:215], a[24:27], a[52:55], v[200:215]
    ds_read_b64_tr_b16 a[20:21], v10 offset:28672
    ds_read_b64_tr_b16 a[22:23], v10 offset:29696
    v_rcp_f32 v241, v241
    v_fma_f32 v242, v242, v154, v154
    v_mul_f32 v243, v152, v35
    v_mfma_f32_32x32x16_bf16 v[216:231], a[28:31], a[52:55], v[216:231]
    ds_read_b64_tr_b16 a[24:25], v9 offset:32768
    ds_read_b64_tr_b16 a[26:27], v9 offset:33792
    v_exp_f32 v243, v243
    v_mul_f32 v241, v241, v41
    s_waitcnt lgkmcnt(6)
    v_mfma_f32_32x32x16_bf16 v[200:215], a[0:3], a[56:59], v[200:215]
    ds_read_b64_tr_b16 a[28:29], v10 offset:32768
    ds_read_b64_tr_b16 a[30:31], v10 offset:33792
    v_rcp_f32 v242, v242
    v_fma_f32 v243, v243, v154, v154
    v_mul_f32 v244, v152, v36
    v_mfma_f32_32x32x16_bf16 v[216:231], a[4:7], a[56:59], v[216:231]
    ds_read_b64_tr_b16 a[0:1], v9 offset:36864
    ds_read_b64_tr_b16 a[2:3], v9 offset:37888
    v_exp_f32 v244, v244
    v_cvt_pk_bf16_f32 v248, v240, v241
    v_mul_f32 v242, v242, v42
    v_mfma_f32_32x32x16_bf16 v[200:215], a[8:11], a[60:63], v[200:215]
    ds_read_b64_tr_b16 a[4:5], v10 offset:36864
    ds_read_b64_tr_b16 a[6:7], v10 offset:37888
    v_rcp_f32 v243, v243
    v_fma_f32 v244, v244, v154, v154
    v_mul_f32 v245, v152, v37
    v_mfma_f32_32x32x16_bf16 v[216:231], a[12:15], a[60:63], v[216:231]
    ds_read_b64_tr_b16 a[8:9], v9 offset:40960
    ds_read_b64_tr_b16 a[10:11], v9 offset:41984
    v_exp_f32 v245, v245
    v_mul_f32 v243, v243, v43
    s_waitcnt lgkmcnt(6)
    v_mfma_f32_32x32x16_bf16 v[200:215], a[16:19], a[64:67], v[200:215]
    ds_read_b64_tr_b16 a[12:13], v10 offset:40960
    ds_read_b64_tr_b16 a[14:15], v10 offset:41984
    v_rcp_f32 v244, v244
    v_fma_f32 v245, v245, v154, v154
    v_mul_f32 v240, v152, v38
    v_mfma_f32_32x32x16_bf16 v[216:231], a[20:23], a[64:67], v[216:231]
    s_waitcnt vmcnt(23)
    s_barrier
    ds_read_b64_tr_b16 a[16:17], v9 offset:45056
    ds_read_b64_tr_b16 a[18:19], v9 offset:46080
    v_exp_f32 v240, v240
    v_cvt_pk_bf16_f32 v249, v242, v243
    v_mul_f32 v244, v244, v44
    v_mfma_f32_32x32x16_bf16 v[200:215], a[24:27], a[68:71], v[200:215]
    ds_read_b64_tr_b16 a[20:21], v10 offset:45056
    ds_read_b64_tr_b16 a[22:23], v10 offset:46080
    v_rcp_f32 v245, v245
    v_fma_f32 v240, v240, v154, v154
    v_mul_f32 v241, v152, v39
    v_mfma_f32_32x32x16_bf16 v[216:231], a[28:31], a[68:71], v[216:231]
    ds_read_b64_tr_b16 a[24:25], v9 offset:49152
    ds_read_b64_tr_b16 a[26:27], v9 offset:50176
    v_exp_f32 v241, v241
    v_mul_f32 v245, v245, v45
    s_waitcnt lgkmcnt(6)
    v_mfma_f32_32x32x16_bf16 v[200:215], a[0:3], a[72:75], v[200:215]
    ds_read_b64_tr_b16 a[28:29], v10 offset:49152
    ds_read_b64_tr_b16 a[30:31], v10 offset:50176
    s_waitcnt vmcnt(4)
    s_mov_b64 exec, 1
    buffer_atomic_add v2, off, s[48:51], s20
    s_mov_b64 exec, -1
    v_rcp_f32 v240, v240
    v_fma_f32 v241, v241, v154, v154
    v_mul_f32 v242, v152, v48
    v_mfma_f32_32x32x16_bf16 v[216:231], a[4:7], a[72:75], v[216:231]
    ds_read_b64_tr_b16 a[0:1], v9 offset:53248
    ds_read_b64_tr_b16 a[2:3], v9 offset:54272
    v_exp_f32 v242, v242
    v_cvt_pk_bf16_f32 v250, v244, v245
    v_mul_f32 v240, v240, v46
    v_mfma_f32_32x32x16_bf16 v[200:215], a[8:11], a[76:79], v[200:215]
    ds_read_b64_tr_b16 a[4:5], v10 offset:53248
    ds_read_b64_tr_b16 a[6:7], v10 offset:54272
    v_rcp_f32 v241, v241
    v_fma_f32 v242, v242, v154, v154
    v_mul_f32 v243, v152, v49
    v_mfma_f32_32x32x16_bf16 v[216:231], a[12:15], a[76:79], v[216:231]
    ds_read_b64_tr_b16 a[8:9], v11 offset:36864
    ds_read_b64_tr_b16 a[10:11], v11 offset:37888
    v_exp_f32 v243, v243
    v_mul_f32 v241, v241, v47
    s_waitcnt lgkmcnt(6)
    v_mfma_f32_32x32x16_bf16 v[200:215], a[16:19], a[80:83], v[200:215]
    ds_read_b64_tr_b16 a[12:13], v12 offset:36864
    ds_read_b64_tr_b16 a[14:15], v12 offset:37888
    v_rcp_f32 v242, v242
    v_fma_f32 v243, v243, v154, v154
    v_mul_f32 v244, v152, v50
    v_mfma_f32_32x32x16_bf16 v[216:231], a[20:23], a[80:83], v[216:231]
    ds_read_b64_tr_b16 a[16:17], v9 offset:57344
    ds_read_b64_tr_b16 a[18:19], v9 offset:58368
    v_exp_f32 v244, v244
    v_cvt_pk_bf16_f32 v251, v240, v241
    v_mul_f32 v242, v242, v56
    v_mfma_f32_32x32x16_bf16 v[200:215], a[24:27], a[84:87], v[200:215]
    ds_read_b64_tr_b16 a[20:21], v10 offset:57344
    ds_read_b64_tr_b16 a[22:23], v10 offset:58368
    buffer_store_dwordx4 v[248:251], v1, s[48:51], s13 offen offset:2048 sc1
    v_rcp_f32 v243, v243
    v_fma_f32 v244, v244, v154, v154
    v_mul_f32 v245, v152, v51
    v_mfma_f32_32x32x16_bf16 v[216:231], a[28:31], a[84:87], v[216:231]
    ds_read_b64_tr_b16 a[24:25], v11 offset:40960
    ds_read_b64_tr_b16 a[26:27], v11 offset:41984
    v_exp_f32 v245, v245
    v_mul_f32 v243, v243, v57
    s_waitcnt lgkmcnt(6)
    v_mfma_f32_32x32x16_bf16 v[200:215], a[0:3], a[88:91], v[200:215]
    ds_read_b64_tr_b16 a[28:29], v12 offset:40960
    ds_read_b64_tr_b16 a[30:31], v12 offset:41984
    v_rcp_f32 v244, v244
    v_fma_f32 v245, v245, v154, v154
    v_mul_f32 v240, v152, v52
    v_mfma_f32_32x32x16_bf16 v[216:231], a[4:7], a[88:91], v[216:231]
    v_add_u32 v9, 61440, v9
    ds_read_b64_tr_b16 a[0:1], v9 offset:0
    ds_read_b64_tr_b16 a[2:3], v9 offset:1024
    v_exp_f32 v240, v240
    v_cvt_pk_bf16_f32 v252, v242, v243
    v_mul_f32 v244, v244, v58
    v_mfma_f32_32x32x16_bf16 v[64:79], a[8:11], a[40:43], 0
    v_add_u32 v10, 61440, v10
    ds_read_b64_tr_b16 a[4:5], v10 offset:0
    ds_read_b64_tr_b16 a[6:7], v10 offset:1024
    v_rcp_f32 v245, v245
    v_fma_f32 v240, v240, v154, v154
    v_mul_f32 v241, v152, v53
    v_mfma_f32_32x32x16_bf16 v[80:95], a[12:15], a[40:43], 0
    ds_read_b64_tr_b16 a[8:9], v11 offset:45056
    ds_read_b64_tr_b16 a[10:11], v11 offset:46080
    v_exp_f32 v241, v241
    v_mul_f32 v245, v245, v59
    s_waitcnt lgkmcnt(6)
    v_mfma_f32_32x32x16_bf16 v[200:215], a[16:19], a[92:95], v[200:215]
    ds_read_b64_tr_b16 a[12:13], v12 offset:45056
    ds_read_b64_tr_b16 a[14:15], v12 offset:46080
    v_rcp_f32 v240, v240
    v_fma_f32 v241, v241, v154, v154
    v_mul_f32 v242, v152, v54
    v_mfma_f32_32x32x16_bf16 v[216:231], a[20:23], a[92:95], v[216:231]
    ds_read_b64_tr_b16 a[16:17], v9 offset:4096
    ds_read_b64_tr_b16 a[18:19], v9 offset:5120
    v_exp_f32 v242, v242
    v_cvt_pk_bf16_f32 v253, v244, v245
    v_mul_f32 v240, v240, v60
    v_mfma_f32_32x32x16_bf16 v[64:79], a[24:27], a[44:47], v[64:79]
    ds_read_b64_tr_b16 a[20:21], v10 offset:4096
    ds_read_b64_tr_b16 a[22:23], v10 offset:5120
    v_rcp_f32 v241, v241
    v_fma_f32 v242, v242, v154, v154
    v_mul_f32 v243, v152, v55
    v_mfma_f32_32x32x16_bf16 v[80:95], a[28:31], a[44:47], v[80:95]
    ds_read_b64_tr_b16 a[24:25], v11 offset:49152
    ds_read_b64_tr_b16 a[26:27], v11 offset:50176
    v_exp_f32 v243, v243
    v_mul_f32 v241, v241, v61
    s_waitcnt lgkmcnt(6)
    v_mfma_f32_32x32x16_bf16 v[200:215], a[0:3], a[96:99], v[200:215]
    ds_read_b64_tr_b16 a[28:29], v12 offset:49152
    ds_read_b64_tr_b16 a[30:31], v12 offset:50176
    v_rcp_f32 v242, v242
    v_fma_f32 v243, v243, v154, v154
    v_mfma_f32_32x32x16_bf16 v[216:231], a[4:7], a[96:99], v[216:231]
    ds_read_b64_tr_b16 a[0:1], v9 offset:8192
    ds_read_b64_tr_b16 a[2:3], v9 offset:9216
    v_cvt_pk_bf16_f32 v254, v240, v241
    v_mul_f32 v242, v242, v62
    v_mfma_f32_32x32x16_bf16 v[64:79], a[8:11], a[48:51], v[64:79]
    ds_read_b64_tr_b16 a[4:5], v10 offset:8192
    ds_read_b64_tr_b16 a[6:7], v10 offset:9216
    v_rcp_f32 v243, v243
    v_mfma_f32_32x32x16_bf16 v[80:95], a[12:15], a[48:51], v[80:95]
    ds_read_b64_tr_b16 a[8:9], v11 offset:53248
    ds_read_b64_tr_b16 a[10:11], v11 offset:54272
    v_mul_f32 v243, v243, v63
    s_waitcnt lgkmcnt(6)
    v_mfma_f32_32x32x16_bf16 v[200:215], a[16:19], a[100:103], v[200:215]
    ds_read_b64_tr_b16 a[12:13], v12 offset:53248
    ds_read_b64_tr_b16 a[14:15], v12 offset:54272
    v_mfma_f32_32x32x16_bf16 v[216:231], a[20:23], a[100:103], v[216:231]
    ds_read_b64_tr_b16 a[16:17], v9 offset:12288
    ds_read_b64_tr_b16 a[18:19], v9 offset:13312
    v_cvt_pk_bf16_f32 v255, v242, v243
    v_mfma_f32_32x32x16_bf16 v[64:79], a[24:27], a[52:55], v[64:79]
    ds_read_b64_tr_b16 a[20:21], v10 offset:12288
    ds_read_b64_tr_b16 a[22:23], v10 offset:13312
    buffer_store_dwordx4 v[252:255], v1, s[48:51], s13 offen offset:3072 sc1
    s_add_u32 s59, s21, 0
    v_mov_b32 v3, 0
    s_mov_b64 exec, 1
    buffer_atomic_umax v3, off, s[48:51], s59 sc0
    s_mov_b64 exec, -1
    v_mfma_f32_32x32x16_bf16 v[80:95], a[28:31], a[52:55], v[80:95]
    s_barrier
    v_add_u32 v11, 61440, v11
    ds_read_b64_tr_b16 a[24:25], v11 offset:24576
    ds_read_b64_tr_b16 a[26:27], v11 offset:25600
    s_waitcnt lgkmcnt(6)
    v_mfma_f32_32x32x16_bf16 v[200:215], a[0:3], a[104:107], v[200:215]
    s_add_u32 m0, s64, 0x9000
    v_add_u32 v12, 61440, v12
    ds_read_b64_tr_b16 a[28:29], v12 offset:24576
    ds_read_b64_tr_b16 a[30:31], v12 offset:25600
    buffer_load_dwordx4 v136, s[40:43], s34 offen lds
    v_mfma_f32_32x32x16_bf16 v[216:231], a[4:7], a[104:107], v[216:231]
    ds_read_b64_tr_b16 a[0:1], v9 offset:16384
    ds_read_b64_tr_b16 a[2:3], v9 offset:17408
    v_mfma_f32_32x32x16_bf16 v[64:79], a[8:11], a[56:59], v[64:79]
    s_add_u32 m0, s64, 0xa000
    ds_read_b64_tr_b16 a[4:5], v10 offset:16384
    ds_read_b64_tr_b16 a[6:7], v10 offset:17408
    buffer_load_dwordx4 v137, s[40:43], s34 offen lds
    v_mfma_f32_32x32x16_bf16 v[80:95], a[12:15], a[56:59], v[80:95]
    ds_read_b64_tr_b16 a[8:9], v11 offset:28672
    ds_read_b64_tr_b16 a[10:11], v11 offset:29696
    s_waitcnt lgkmcnt(6)
    v_mfma_f32_32x32x16_bf16 v[200:215], a[16:19], a[108:111], v[200:215]
    s_add_u32 m0, s64, 0xb000
    ds_read_b64_tr_b16 a[12:13], v12 offset:28672
    ds_read_b64_tr_b16 a[14:15], v12 offset:29696
    buffer_load_dwordx4 v138, s[40:43], s24 offen lds
    v_mfma_f32_32x32x16_bf16 v[216:231], a[20:23], a[108:111], v[216:231]
    s_barrier
    ds_read_b64_tr_b16 a[16:17], v9 offset:20480
    ds_read_b64_tr_b16 a[18:19], v9 offset:21504
    v_mfma_f32_32x32x16_bf16 v[64:79], a[24:27], a[60:63], v[64:79]
    s_add_u32 m0, s64, 0xc000
    ds_read_b64_tr_b16 a[20:21], v10 offset:20480
    ds_read_b64_tr_b16 a[22:23], v10 offset:21504
    buffer_load_dwordx4 v139, s[40:43], s24 offen lds
    v_mfma_f32_32x32x16_bf16 v[80:95], a[28:31], a[60:63], v[80:95]
    ds_read_b64_tr_b16 a[24:25], v11 offset:32768
    ds_read_b64_tr_b16 a[26:27], v11 offset:33792
    s_waitcnt lgkmcnt(6)
    v_mfma_f32_32x32x16_bf16 v[200:215], a[0:3], a[112:115], v[200:215]
    ds_read_b64_tr_b16 a[28:29], v12 offset:32768
    ds_read_b64_tr_b16 a[30:31], v12 offset:33792
    v_mfma_f32_32x32x16_bf16 v[216:231], a[4:7], a[112:115], v[216:231]
    ds_read_b64_tr_b16 a[0:1], v9 offset:24576
    ds_read_b64_tr_b16 a[2:3], v9 offset:25600
    v_mfma_f32_32x32x16_bf16 v[64:79], a[8:11], a[64:67], v[64:79]
    ds_read_b64_tr_b16 a[4:5], v10 offset:24576
    ds_read_b64_tr_b16 a[6:7], v10 offset:25600
    v_mfma_f32_32x32x16_bf16 v[80:95], a[12:15], a[64:67], v[80:95]
    ds_read_b64_tr_b16 a[8:9], v11 offset:36864
    ds_read_b64_tr_b16 a[10:11], v11 offset:37888
    s_waitcnt lgkmcnt(6)
    v_mfma_f32_32x32x16_bf16 v[200:215], a[16:19], a[116:119], v[200:215]
    ds_read_b64_tr_b16 a[12:13], v12 offset:36864
    ds_read_b64_tr_b16 a[14:15], v12 offset:37888
    v_mfma_f32_32x32x16_bf16 v[216:231], a[20:23], a[116:119], v[216:231]
    ds_read_b64_tr_b16 a[16:17], v9 offset:28672
    ds_read_b64_tr_b16 a[18:19], v9 offset:29696
    v_mfma_f32_32x32x16_bf16 v[64:79], a[24:27], a[68:71], v[64:79]
    ds_read_b64_tr_b16 a[20:21], v10 offset:28672
    ds_read_b64_tr_b16 a[22:23], v10 offset:29696
    v_mfma_f32_32x32x16_bf16 v[80:95], a[28:31], a[68:71], v[80:95]
    s_barrier
    ds_read_b64_tr_b16 a[24:25], v11 offset:40960
    ds_read_b64_tr_b16 a[26:27], v11 offset:41984
    s_waitcnt lgkmcnt(6)
    v_mfma_f32_32x32x16_bf16 v[200:215], a[0:3], a[120:123], v[200:215]
    s_add_u32 m0, s64, 0xd000
    ds_read_b64_tr_b16 a[28:29], v12 offset:40960
    ds_read_b64_tr_b16 a[30:31], v12 offset:41984
    buffer_load_dwordx4 v138, s[40:43], s25 offen lds
    v_mfma_f32_32x32x16_bf16 v[216:231], a[4:7], a[120:123], v[216:231]
    ds_read_b64_tr_b16 a[0:1], v9 offset:32768
    ds_read_b64_tr_b16 a[2:3], v9 offset:33792
    v_mfma_f32_32x32x16_bf16 v[64:79], a[8:11], a[72:75], v[64:79]
    ds_read_b64_tr_b16 a[4:5], v10 offset:32768
    ds_read_b64_tr_b16 a[6:7], v10 offset:33792
    s_waitcnt vmcnt(6)
    s_mov_b64 exec, 1
    buffer_atomic_add v2, off, s[48:51], s20 offset:128
    s_mov_b64 exec, -1
    s_add_u32 m0, s64, 0x15000
    s_nop 0
    buffer_load_dwordx4 v139, s[40:43], s25 offen lds
    v_mfma_f32_32x32x16_bf16 v[80:95], a[12:15], a[72:75], v[80:95]
    ds_read_b64_tr_b16 a[8:9], v11 offset:45056
    ds_read_b64_tr_b16 a[10:11], v11 offset:46080
    s_waitcnt lgkmcnt(6)
    v_mfma_f32_32x32x16_bf16 v[200:215], a[16:19], a[124:127], v[200:215]
    s_add_u32 m0, s64, 0x16000
    ds_read_b64_tr_b16 a[12:13], v12 offset:45056
    ds_read_b64_tr_b16 a[14:15], v12 offset:46080
    buffer_load_dwordx4 v138, s[40:43], s26 offen lds
    v_mfma_f32_32x32x16_bf16 v[216:231], a[20:23], a[124:127], v[216:231]
    ds_read_b64_tr_b16 a[16:17], v9 offset:36864
    ds_read_b64_tr_b16 a[18:19], v9 offset:37888
    v_mfma_f32_32x32x16_bf16 v[64:79], a[24:27], a[76:79], v[64:79]
    ds_read_b64_tr_b16 a[20:21], v10 offset:36864
    ds_read_b64_tr_b16 a[22:23], v10 offset:37888
    s_waitcnt vmcnt(8)
    v_readfirstlane_b32 s3, v3
    s_nop 0
    s_cmp_ge_u32 s3, 7
    s_cbranch_scc1 L_ok5
    s_mov_b32 s58, 100000
L_spin5:
    s_mov_b64 exec, 1
    buffer_atomic_umax v3, off, s[48:51], s59 sc0
    s_mov_b64 exec, -1
    s_waitcnt vmcnt(0)
    v_readfirstlane_b32 s3, v3
    s_nop 0
    s_cmp_ge_u32 s3, 7
    s_cbranch_scc1 L_ok5
    s_sub_u32 s58, s58, 1
    s_cmp_lg_u32 s58, 0
    s_cbranch_scc1 L_spin5
L_ok5:
    v_mfma_f32_32x32x16_bf16 v[80:95], a[28:31], a[76:79], v[80:95]
    ds_read_b64_tr_b16 a[24:25], v11 offset:49152
    ds_read_b64_tr_b16 a[26:27], v11 offset:50176
    buffer_load_dwordx4 a[172:175], v1, s[48:51], s0 offen sc1
    s_waitcnt lgkmcnt(6)
    v_mfma_f32_32x32x16_bf16 v[200:215], a[0:3], a[128:131], v[200:215]
    ds_read_b64_tr_b16 a[28:29], v12 offset:49152
    ds_read_b64_tr_b16 a[30:31], v12 offset:50176
    v_mfma_f32_32x32x16_bf16 v[216:231], a[4:7], a[128:131], v[216:231]
    v_subrev_u32 v9, 122880, v9
    ds_read_b64_tr_b16 a[0:1], v9 offset:57344
    ds_read_b64_tr_b16 a[2:3], v9 offset:58368
    buffer_load_dwordx4 a[176:179], v1, s[48:51], s0 offen offset:1024 sc1
    v_mfma_f32_32x32x16_bf16 v[64:79], a[8:11], a[80:83], v[64:79]
    v_subrev_u32 v10, 122880, v10
    ds_read_b64_tr_b16 a[4:5], v10 offset:57344
    ds_read_b64_tr_b16 a[6:7], v10 offset:58368
    v_mfma_f32_32x32x16_bf16 v[80:95], a[12:15], a[80:83], v[80:95]
    ds_read_b64_tr_b16 a[8:9], v11 offset:53248
    ds_read_b64_tr_b16 a[10:11], v11 offset:54272
    buffer_load_dwordx4 a[180:183], v1, s[48:51], s1 offen sc1
    s_waitcnt lgkmcnt(6)
    v_mfma_f32_32x32x16_bf16 v[200:215], a[16:19], a[132:135], v[200:215]
    ds_read_b64_tr_b16 a[12:13], v12 offset:53248
    ds_read_b64_tr_b16 a[14:15], v12 offset:54272
    v_mfma_f32_32x32x16_bf16 v[216:231], a[20:23], a[132:135], v[216:231]
    v_add_u32 v9, 61440, v9
    ds_read_b64_tr_b16 a[16:17], v9 offset:0
    ds_read_b64_tr_b16 a[18:19], v9 offset:1024
    buffer_load_dwordx4 a[184:187], v1, s[48:51], s1 offen offset:1024 sc1
    v_mfma_f32_32x32x16_bf16 v[64:79], a[24:27], a[84:87], v[64:79]
    v_add_u32 v10, 61440, v10
    ds_read_b64_tr_b16 a[20:21], v10 offset:0
    ds_read_b64_tr_b16 a[22:23], v10 offset:1024
    v_mfma_f32_32x32x16_bf16 v[80:95], a[28:31], a[84:87], v[80:95]
    s_barrier
    ds_read_b64_tr_b16 a[24:25], v11 offset:57344
    ds_read_b64_tr_b16 a[26:27], v11 offset:58368
    buffer_load_dwordx4 a[188:191], v1, s[48:51], s16 offen sc1
    s_waitcnt lgkmcnt(6)
    v_mfma_f32_32x32x16_bf16 v[200:215], a[0:3], a[136:139], v[200:215]
    ds_read_b64_tr_b16 a[28:29], v12 offset:57344
    ds_read_b64_tr_b16 a[30:31], v12 offset:58368
    v_mfma_f32_32x32x16_bf16 v[216:231], a[4:7], a[136:139], v[216:231]
    ds_read_b64_tr_b16 a[0:1], v9 offset:4096
    ds_read_b64_tr_b16 a[2:3], v9 offset:5120
    buffer_load_dwordx4 a[192:195], v1, s[48:51], s16 offen offset:1024 sc1
    v_mfma_f32_32x32x16_bf16 v[64:79], a[8:11], a[88:91], v[64:79]
    ds_read_b64_tr_b16 a[4:5], v10 offset:4096
    ds_read_b64_tr_b16 a[6:7], v10 offset:5120
    v_mfma_f32_32x32x16_bf16 v[80:95], a[12:15], a[88:91], v[80:95]
    v_add_u32 v11, 61440, v11
    ds_read_b64_tr_b16 a[8:9], v11 offset:0
    ds_read_b64_tr_b16 a[10:11], v11 offset:1024
    buffer_load_dwordx4 a[196:199], v1, s[48:51], s17 offen sc1
    s_waitcnt lgkmcnt(6)
    v_mfma_f32_32x32x16_bf16 v[200:215], a[16:19], a[140:143], v[200:215]
    v_add_u32 v12, 61440, v12
    ds_read_b64_tr_b16 a[12:13], v12 offset:0
    ds_read_b64_tr_b16 a[14:15], v12 offset:1024
    v_mfma_f32_32x32x16_bf16 v[216:231], a[20:23], a[140:143], v[216:231]
    ds_read_b64_tr_b16 a[16:17], v9 offset:8192
    ds_read_b64_tr_b16 a[18:19], v9 offset:9216
    buffer_load_dwordx4 a[200:203], v1, s[48:51], s17 offen offset:1024 sc1
    v_mfma_f32_32x32x16_bf16 v[64:79], a[24:27], a[92:95], v[64:79]
    ds_read_b64_tr_b16 a[20:21], v10 offset:8192
    ds_read_b64_tr_b16 a[22:23], v10 offset:9216
    v_mfma_f32_32x32x16_bf16 v[80:95], a[28:31], a[92:95], v[80:95]
    ds_read_b64_tr_b16 a[24:25], v11 offset:4096
    ds_read_b64_tr_b16 a[26:27], v11 offset:5120
    buffer_load_dwordx4 a[204:207], v1, s[48:51], s19 offen sc1
    s_waitcnt lgkmcnt(6)
    v_mfma_f32_32x32x16_bf16 v[200:215], a[0:3], a[144:147], v[200:215]
    ds_read_b64_tr_b16 a[28:29], v12 offset:4096
    ds_read_b64_tr_b16 a[30:31], v12 offset:5120
    s_add_u32 s59, s21, 128
    v_mov_b32 v3, 0
    s_mov_b64 exec, 1
    buffer_atomic_umax v3, off, s[48:51], s59 sc0
    s_mov_b64 exec, -1
    v_mfma_f32_32x32x16_bf16 v[216:231], a[4:7], a[144:147], v[216:231]
    ds_read_b64_tr_b16 a[0:1], v11 offset:8192
    ds_read_b64_tr_b16 a[2:3], v11 offset:9216
    buffer_load_dwordx4 a[208:211], v1, s[48:51], s19 offen offset:1024 sc1
    v_mfma_f32_32x32x16_bf16 v[64:79], a[8:11], a[96:99], v[64:79]
    ds_read_b64_tr_b16 a[4:5], v12 offset:8192
    ds_read_b64_tr_b16 a[6:7], v12 offset:9216
    v_mfma_f32_32x32x16_bf16 v[80:95], a[12:15], a[96:99], v[80:95]
    ds_read_b64_tr_b16 a[8:9], v11 offset:12288
    ds_read_b64_tr_b16 a[10:11], v11 offset:13312
    buffer_load_dwordx4 a[212:215], v1, s[48:51], s23 offen sc1
    s_waitcnt lgkmcnt(6)
    v_mfma_f32_32x32x16_bf16 v[200:215], a[16:19], a[148:151], v[200:215]
    ds_read_b64_tr_b16 a[12:13], v12 offset:12288
    ds_read_b64_tr_b16 a[14:15], v12 offset:13312
    v_mfma_f32_32x32x16_bf16 v[216:231], a[20:23], a[148:151], v[216:231]
    ds_read_b64_tr_b16 a[16:17], v11 offset:16384
    ds_read_b64_tr_b16 a[18:19], v11 offset:17408
    buffer_load_dwordx4 a[216:219], v1, s[48:51], s23 offen offset:1024 sc1
    v_mfma_f32_32x32x16_bf16 v[200:215], a[160:163], v[148:151], v[200:215]
    v_mfma_f32_32x32x16_bf16 v[216:231], a[162:165], v[148:151], v[216:231]
    buffer_load_dwordx4 a[220:223], v1, s[48:51], s55 offen sc1
    v_mfma_f32_32x32x16_bf16 v[64:79], a[24:27], a[100:103], v[64:79]
    ds_read_b64_tr_b16 a[20:21], v12 offset:16384
    ds_read_b64_tr_b16 a[22:23], v12 offset:17408
    s_nop 6
    v_mul_f32 v240, v152, v200
    v_mfma_f32_32x32x16_bf16 v[80:95], a[28:31], a[100:103], v[80:95]
    s_barrier
    ds_read_b64_tr_b16 a[24:25], v11 offset:20480
    ds_read_b64_tr_b16 a[26:27], v11 offset:21504
    buffer_load_dwordx4 a[224:227], v1, s[48:51], s55 offen offset:1024 sc1
    v_exp_f32 v240, v240
    s_waitcnt lgkmcnt(6)
    v_mfma_f32_32x32x16_bf16 v[64:79], a[0:3], a[104:107], v[64:79]
    ds_read_b64_tr_b16 a[28:29], v12 offset:20480
    ds_read_b64_tr_b16 a[30:31], v12 offset:21504
    v_fma_f32 v240, v240, v154, v154
    v_mul_f32 v241, v152, v201
    v_mfma_f32_32x32x16_bf16 v[80:95], a[4:7], a[104:107], v[80:95]
    s_add_u32 m0, s64, 0x17000
    ds_read_b64_tr_b16 a[0:1], v11 offset:24576
    ds_read_b64_tr_b16 a[2:3], v11 offset:25600
    buffer_load_dwordx4 v139, s[40:43], s26 offen lds
    v_exp_f32 v241, v241
    v_mfma_f32_32x32x16_bf16 v[64:79], a[8:11], a[108:111], v[64:79]
    ds_read_b64_tr_b16 a[4:5], v12 offset:24576
    ds_read_b64_tr_b16 a[6:7], v12 offset:25600
    v_rcp_f32 v240, v240
    v_fma_f32 v241, v241, v154, v154
    v_mul_f32 v242, v152, v202
    v_mfma_f32_32x32x16_bf16 v[80:95], a[12:15], a[108:111], v[80:95]
    s_add_u32 m0, s64, 0x18000
    ds_read_b64_tr_b16 a[8:9], v11 offset:28672
    ds_read_b64_tr_b16 a[10:11], v11 offset:29696
    buffer_load_dwordx4 v138, s[40:43], s27 offen lds
    v_exp_f32 v242, v242
    v_mul_f32 v240, v240, v208
    s_waitcnt lgkmcnt(6)
    v_mfma_f32_32x32x16_bf16 v[64:79], a[16:19], a[112:115], v[64:79]
    ds_read_b64_tr_b16 a[12:13], v12 offset:28672
    ds_read_b64_tr_b16 a[14:15], v12 offset:29696
    v_rcp_f32 v241, v241
    v_fma_f32 v242, v242, v154, v154
    v_mul_f32 v243, v152, v203
    v_mfma_f32_32x32x16_bf16 v[80:95], a[20:23], a[112:115], v[80:95]
    s_add_u32 m0, s64, 0x19000
    ds_read_b64_tr_b16 a[16:17], v11 offset:32768
    ds_read_b64_tr_b16 a[18:19], v11 offset:33792
    buffer_load_dwordx4 v139, s[40:43], s27 offen lds
    v_exp_f32 v243, v243
    v_mul_f32 v241, v241, v209
    v_mfma_f32_32x32x16_bf16 v[64:79], a[24:27], a[116:119], v[64:79]
    ds_read_b64_tr_b16 a[20:21], v12 offset:32768
    ds_read_b64_tr_b16 a[22:23], v12 offset:33792
    v_rcp_f32 v242, v242
    v_fma_f32 v243, v243, v154, v154
    v_mul_f32 v244, v152, v204
    v_mfma_f32_32x32x16_bf16 v[80:95], a[28:31], a[116:119], v[80:95]
    s_barrier
    s_add_u32 m0, s64, 0x1a000
    ds_read_b64_tr_b16 a[24:25], v11 offset:36864
    ds_read_b64_tr_b16 a[26:27], v11 offset:37888
    buffer_load_dwordx4 v138, s[40:43], s32 offen lds
    v_exp_f32 v244, v244
    v_cvt_pk_bf16_f32 v248, v240, v241
    v_mul_f32 v242, v242, v210
    s_waitcnt lgkmcnt(6)
    v_mfma_f32_32x32x16_bf16 v[64:79], a[0:3], a[120:123], v[64:79]
    ds_read_b64_tr_b16 a[28:29], v12 offset:36864
    ds_read_b64_tr_b16 a[30:31], v12 offset:37888
    v_rcp_f32 v243, v243
    v_fma_f32 v244, v244, v154, v154
    v_mul_f32 v245, v152, v205
    v_mfma_f32_32x32x16_bf16 v[80:95], a[4:7], a[120:123], v[80:95]
    s_add_u32 m0, s64, 0x1b000
    v_subrev_u32 v11, 122880, v11
    ds_read_b64_tr_b16 a[0:1], v11 offset:57344
    ds_read_b64_tr_b16 a[2:3], v11 offset:58368
    buffer_load_dwordx4 v139, s[40:43], s32 offen lds
    v_exp_f32 v245, v245
    v_mul_f32 v243, v243, v211
    v_mfma_f32_32x32x16_bf16 v[64:79], a[8:11], a[124:127], v[64:79]
    v_subrev_u32 v12, 122880, v12
    ds_read_b64_tr_b16 a[4:5], v12 offset:57344
    ds_read_b64_tr_b16 a[6:7], v12 offset:58368
    v_rcp_f32 v244, v244
    v_fma_f32 v245, v245, v154, v154
    v_mul_f32 v240, v152, v206
    v_mfma_f32_32x32x16_bf16 v[80:95], a[12:15], a[124:127], v[80:95]
    s_add_u32 m0, s64, 0x1c000
    v_add_u32 v11, 61440, v11
    ds_read_b64_tr_b16 a[8:9], v11 offset:0
    ds_read_b64_tr_b16 a[10:11], v11 offset:1024
    buffer_load_dwordx4 v138, s[40:43], s33 offen lds
    v_exp_f32 v240, v240
    v_cvt_pk_bf16_f32 v249, v242, v243
    v_mul_f32 v244, v244, v212
    s_waitcnt lgkmcnt(6)
    v_mfma_f32_32x32x16_bf16 v[64:79], a[16:19], a[128:131], v[64:79]
    v_add_u32 v12, 61440, v12
    ds_read_b64_tr_b16 a[12:13], v12 offset:0
    ds_read_b64_tr_b16 a[14:15], v12 offset:1024
    v_rcp_f32 v245, v245
    v_fma_f32 v240, v240, v154, v154
    v_mul_f32 v241, v152, v207
    v_mfma_f32_32x32x16_bf16 v[80:95], a[20:23], a[128:131], v[80:95]
    s_add_u32 m0, s64, 0x1d000
    ds_read_b64_tr_b16 a[16:17], v11 offset:4096
    ds_read_b64_tr_b16 a[18:19], v11 offset:5120
    buffer_load_dwordx4 v139, s[40:43], s33 offen lds
    v_exp_f32 v241, v241
    v_mul_f32 v245, v245, v213
    v_mfma_f32_32x32x16_bf16 v[64:79], a[24:27], a[132:135], v[64:79]
    ds_read_b64_tr_b16 a[20:21], v12 offset:4096
    ds_read_b64_tr_b16 a[22:23], v12 offset:5120
    s_waitcnt vmcnt(12)
    v_readfirstlane_b32 s3, v3
    s_nop 0
    s_cmp_ge_u32 s3, 7
    s_cbranch_scc1 L_ok6
    s_mov_b32 s58, 100000
L_spin6:
    s_mov_b64 exec, 1
    buffer_atomic_umax v3, off, s[48:51], s59 sc0
    s_mov_b64 exec, -1
    s_waitcnt vmcnt(0)
    v_readfirstlane_b32 s3, v3
    s_nop 0
    s_cmp_ge_u32 s3, 7
    s_cbranch_scc1 L_ok6
    s_sub_u32 s58, s58, 1
    s_cmp_lg_u32 s58, 0
    s_cbranch_scc1 L_spin6
L_ok6:
    v_rcp_f32 v240, v240
    v_fma_f32 v241, v241, v154, v154
    v_mul_f32 v242, v152, v216
    v_mfma_f32_32x32x16_bf16 v[80:95], a[28:31], a[132:135], v[80:95]
    s_barrier
    ds_read_b64_tr_b16 a[24:25], v11 offset:8192
    ds_read_b64_tr_b16 a[26:27], v11 offset:9216
    buffer_load_dwordx4 a[228:231], v1, s[48:51], s0 offen offset:2048 sc1
    v_exp_f32 v242, v242
    v_cvt_pk_bf16_f32 v250, v244, v245
    v_mul_f32 v240, v240, v214
    s_waitcnt lgkmcnt(6)
    v_mfma_f32_32x32x16_bf16 v[64:79], a[0:3], a[136:139], v[64:79]
    ds_read_b64_tr_b16 a[28:29], v12 offset:8192
    ds_read_b64_tr_b16 a[30:31], v12 offset:9216
    v_rcp_f32 v241, v241
    v_fma_f32 v242, v242, v154, v154
    v_mul_f32 v243, v152, v217
    v_mfma_f32_32x32x16_bf16 v[80:95], a[4:7], a[136:139], v[80:95]
    buffer_load_dwordx4 a[232:235], v1, s[48:51], s0 offen offset:3072 sc1
    v_exp_f32 v243, v243
    v_mul_f32 v241, v241, v215
    v_mfma_f32_32x32x16_bf16 v[64:79], a[8:11], a[140:143], v[64:79]
    v_rcp_f32 v242, v242
    v_fma_f32 v243, v243, v154, v154
    v_mul_f32 v244, v152, v218
    v_mfma_f32_32x32x16_bf16 v[80:95], a[12:15], a[140:143], v[80:95]
    buffer_load_dwordx4 a[236:239], v1, s[48:51], s1 offen offset:2048 sc1
    v_exp_f32 v244, v244
    v_cvt_pk_bf16_f32 v251, v240, v241
    v_mul_f32 v242, v242, v224
    s_waitcnt lgkmcnt(0)
    v_mfma_f32_32x32x16_bf16 v[64:79], a[16:19], a[144:147], v[64:79]
    buffer_store_dwordx4 v[248:251], v144, s[48:51], s13 offen sc1
    v_rcp_f32 v243, v243
    v_fma_f32 v244, v244, v154, v154
    v_mul_f32 v245, v152, v219
    v_mfma_f32_32x32x16_bf16 v[80:95], a[20:23], a[144:147], v[80:95]
    buffer_load_dwordx4 a[240:243], v1, s[48:51], s1 offen offset:3072 sc1
    v_exp_f32 v245, v245
    v_mul_f32 v243, v243, v225
    v_mfma_f32_32x32x16_bf16 v[64:79], a[24:27], a[148:151], v[64:79]
    v_rcp_f32 v244, v244
    v_fma_f32 v245, v245, v154, v154
    v_mul_f32 v240, v152, v220
    v_mfma_f32_32x32x16_bf16 v[80:95], a[28:31], a[148:151], v[80:95]
    s_barrier
    buffer_load_dwordx4 a[244:247], v1, s[48:51], s16 offen offset:2048 sc1
    v_exp_f32 v240, v240
    v_cvt_pk_bf16_f32 v252, v242, v243
    v_mul_f32 v244, v244, v226
    v_mfma_f32_32x32x16_bf16 v[64:79], a[164:167], v[148:151], v[64:79]
    v_rcp_f32 v245, v245
    v_fma_f32 v240, v240, v154, v154
    v_mul_f32 v241, v152, v221
    v_mfma_f32_32x32x16_bf16 v[80:95], a[166:169], v[148:151], v[80:95]
    buffer_load_dwordx4 a[248:251], v1, s[48:51], s16 offen offset:3072 sc1
    v_exp_f32 v241, v241
    v_mul_f32 v245, v245, v227
    v_rcp_f32 v240, v240
    v_fma_f32 v241, v241, v154, v154
    v_mul_f32 v242, v152, v222
    v_exp_f32 v242, v242
    v_cvt_pk_bf16_f32 v253, v244, v245
    v_mul_f32 v240, v240, v228
    v_rcp_f32 v241, v241
    v_fma_f32 v242, v242, v154, v154
    v_mul_f32 v243, v152, v223
    v_exp_f32 v243, v243
    v_mul_f32 v241, v241, v229
    v_rcp_f32 v242, v242
    v_fma_f32 v243, v243, v154, v154
    v_cvt_pk_bf16_f32 v254, v240, v241
    v_mul_f32 v242, v242, v230
    v_rcp_f32 v243, v243
    s_nop 0
    v_mul_f32 v243, v243, v231
    v_cvt_pk_bf16_f32 v255, v242, v243
    buffer_store_dwordx4 v[252:255], v144, s[48:51], s13 offen offset:1024 sc1
    v_pk_mul_f32 v[164:165], v[64:65], v[152:153] op_sel_hi:[1,0]
    v_pk_mul_f32 v[156:157], v[80:81], v[152:153] op_sel_hi:[1,0]
    v_pk_mul_f32 v[166:167], v[66:67], v[152:153] op_sel_hi:[1,0]
    v_pk_mul_f32 v[158:159], v[82:83], v[152:153] op_sel_hi:[1,0]
    v_pk_mul_f32 v[168:169], v[68:69], v[152:153] op_sel_hi:[1,0]
    v_pk_mul_f32 v[160:161], v[84:85], v[152:153] op_sel_hi:[1,0]
    v_pk_mul_f32 v[170:171], v[70:71], v[152:153] op_sel_hi:[1,0]
    v_pk_mul_f32 v[162:163], v[86:87], v[152:153] op_sel_hi:[1,0]
    v_exp_f32 v164, v164
    v_exp_f32 v156, v156
    v_exp_f32 v166, v166
    v_exp_f32 v158, v158
    v_exp_f32 v168, v168
    v_exp_f32 v160, v160
    v_exp_f32 v170, v170
    v_exp_f32 v162, v162
    v_exp_f32 v165, v165
    v_exp_f32 v157, v157
    v_exp_f32 v167, v167
    v_exp_f32 v159, v159
    v_exp_f32 v169, v169
    v_exp_f32 v161, v161
    v_exp_f32 v171, v171
    v_exp_f32 v163, v163
    v_pk_fma_f32 v[164:165], v[164:165], v[154:155], v[154:155] op_sel_hi:[1,0,0]
    v_pk_fma_f32 v[156:157], v[156:157], v[154:155], v[154:155] op_sel_hi:[1,0,0]
    v_pk_fma_f32 v[166:167], v[166:167], v[154:155], v[154:155] op_sel_hi:[1,0,0]
    v_pk_fma_f32 v[158:159], v[158:159], v[154:155], v[154:155] op_sel_hi:[1,0,0]
    v_pk_fma_f32 v[168:169], v[168:169], v[154:155], v[154:155] op_sel_hi:[1,0,0]
    v_pk_fma_f32 v[160:161], v[160:161], v[154:155], v[154:155] op_sel_hi:[1,0,0]
    v_pk_fma_f32 v[170:171], v[170:171], v[154:155], v[154:155] op_sel_hi:[1,0,0]
    v_pk_fma_f32 v[162:163], v[162:163], v[154:155], v[154:155] op_sel_hi:[1,0,0]
    v_rcp_f32 v164, v164
    v_rcp_f32 v156, v156
    v_rcp_f32 v166, v166
    v_rcp_f32 v158, v158
    v_rcp_f32 v168, v168
    v_rcp_f32 v160, v160
    v_rcp_f32 v170, v170
    v_rcp_f32 v162, v162
    v_rcp_f32 v165, v165
    v_rcp_f32 v157, v157
    v_rcp_f32 v167, v167
    v_rcp_f32 v159, v159
    v_rcp_f32 v169, v169
    v_rcp_f32 v161, v161
    v_rcp_f32 v171, v171
    v_rcp_f32 v163, v163
    v_pk_mul_f32 v[164:165], v[164:165], v[72:73]
    v_pk_mul_f32 v[156:157], v[156:157], v[88:89]
    v_pk_mul_f32 v[166:167], v[166:167], v[74:75]
    v_pk_mul_f32 v[158:159], v[158:159], v[90:91]
    v_pk_mul_f32 v[168:169], v[168:169], v[76:77]
    v_pk_mul_f32 v[160:161], v[160:161], v[92:93]
    v_pk_mul_f32 v[170:171], v[170:171], v[78:79]
    v_pk_mul_f32 v[162:163], v[162:163], v[94:95]
    v_cvt_pk_bf16_f32 v248, v164, v165
    v_cvt_pk_bf16_f32 v252, v156, v157
    v_cvt_pk_bf16_f32 v249, v166, v167
    v_cvt_pk_bf16_f32 v253, v158, v159
    v_cvt_pk_bf16_f32 v250, v168, v169
    v_cvt_pk_bf16_f32 v254, v160, v161
    v_cvt_pk_bf16_f32 v251, v170, v171
    v_cvt_pk_bf16_f32 v255, v162, v163
    buffer_store_dwordx4 v[248:251], v144, s[48:51], s13 offen offset:2048 sc1
    buffer_store_dwordx4 v[252:255], v144, s[48:51], s13 offen offset:3072 sc1
    s_waitcnt vmcnt(2)
    s_mov_b64 exec, 1
    buffer_atomic_add v2, off, s[48:51], s20 offset:256
    s_mov_b64 exec, -1
    buffer_load_dwordx4 a[252:255], v1, s[48:51], s17 offen offset:2048 sc1
    buffer_load_dwordx4 v[172:175], v1, s[48:51], s17 offen offset:3072 sc1
    buffer_load_dwordx4 v[176:179], v1, s[48:51], s19 offen offset:2048 sc1
    buffer_load_dwordx4 v[180:183], v1, s[48:51], s19 offen offset:3072 sc1
    buffer_load_dwordx4 v[184:187], v1, s[48:51], s23 offen offset:2048 sc1
    buffer_load_dwordx4 v[188:191], v1, s[48:51], s23 offen offset:3072 sc1
    s_barrier
    v_add_u32 v14, 61440, v14
    ds_read_b64_tr_b16 a[0:1], v14 offset:12288
    ds_read_b64_tr_b16 a[2:3], v14 offset:13312
    v_add_u32 v15, 61440, v15
    ds_read_b64_tr_b16 a[4:5], v15 offset:12288
    ds_read_b64_tr_b16 a[6:7], v15 offset:13312
    ds_read_b64_tr_b16 a[8:9], v14 offset:16384
    ds_read_b64_tr_b16 a[10:11], v14 offset:17408
    ds_read_b64_tr_b16 a[12:13], v15 offset:16384
    ds_read_b64_tr_b16 a[14:15], v15 offset:17408
    ds_read_b64_tr_b16 a[16:17], v14 offset:20480
    ds_read_b64_tr_b16 a[18:19], v14 offset:21504
    ds_read_b64_tr_b16 a[20:21], v15 offset:20480
    ds_read_b64_tr_b16 a[22:23], v15 offset:21504
    v_subrev_u32 v14, 61440, v14
    ds_read_b64_tr_b16 a[24:25], v14 offset:0
    ds_read_b64_tr_b16 a[26:27], v14 offset:1024
    s_waitcnt lgkmcnt(6)
    v_mfma_f32_32x32x16_bf16 v[96:111], a[0:3], a[172:175], v[96:111]
    v_subrev_u32 v15, 61440, v15
    ds_read_b64_tr_b16 a[28:29], v15 offset:0
    ds_read_b64_tr_b16 a[30:31], v15 offset:1024
    buffer_load_dwordx4 v[192:195], v1, s[48:51], s55 offen offset:2048 sc1
    v_mfma_f32_32x32x16_bf16 v[112:127], a[4:7], a[172:175], 0
    ds_read_b64_tr_b16 a[0:1], v14 offset:4096
    ds_read_b64_tr_b16 a[2:3], v14 offset:5120
    buffer_load_dwordx4 v[196:199], v1, s[48:51], s55 offen offset:3072 sc1
    v_mfma_f32_32x32x16_bf16 v[96:111], a[8:11], a[176:179], v[96:111]
    ds_read_b64_tr_b16 a[4:5], v15 offset:4096
    ds_read_b64_tr_b16 a[6:7], v15 offset:5120
    v_mfma_f32_32x32x16_bf16 v[112:127], a[12:15], a[176:179], v[112:127]
    s_add_u32 m0, s64, 0x1e000
    ds_read_b64_tr_b16 a[8:9], v14 offset:8192
    ds_read_b64_tr_b16 a[10:11], v14 offset:9216
    buffer_load_dwordx4 v138, s[40:43], s34 offen lds
    s_waitcnt lgkmcnt(6)
    v_mfma_f32_32x32x16_bf16 v[96:111], a[16:19], a[180:183], v[96:111]
    s_add_u32 m0, s64, 0x1f000
    ds_read_b64_tr_b16 a[12:13], v15 offset:8192
    ds_read_b64_tr_b16 a[14:15], v15 offset:9216
    buffer_load_dwordx4 v139, s[40:43], s34 offen lds
    v_mfma_f32_32x32x16_bf16 v[112:127], a[20:23], a[180:183], v[112:127]
    ds_read_b64_tr_b16 a[16:17], v14 offset:12288
    ds_read_b64_tr_b16 a[18:19], v14 offset:13312
    v_mfma_f32_32x32x16_bf16 v[96:111], a[24:27], a[184:187], v[96:111]
    s_add_u32 m0, s64, 0x20000
    ds_read_b64_tr_b16 a[20:21], v15 offset:12288
    ds_read_b64_tr_b16 a[22:23], v15 offset:13312
    buffer_load_dwordx4 v140, s[40:43], s24 offen lds
    v_mfma_f32_32x32x16_bf16 v[112:127], a[28:31], a[184:187], v[112:127]
    s_add_u32 m0, s64, 0x21000
    ds_read_b64_tr_b16 a[24:25], v14 offset:16384
    ds_read_b64_tr_b16 a[26:27], v14 offset:17408
    buffer_load_dwordx4 v141, s[40:43], s24 offen lds
    s_waitcnt lgkmcnt(6)
    v_mfma_f32_32x32x16_bf16 v[96:111], a[0:3], a[188:191], v[96:111]
    ds_read_b64_tr_b16 a[28:29], v15 offset:16384
    ds_read_b64_tr_b16 a[30:31], v15 offset:17408
    s_waitcnt vmcnt(13)
    s_add_u32 s59, s21, 256
    v_mov_b32 v3, 0
    s_mov_b64 exec, 1
    buffer_atomic_umax v3, off, s[48:51], s59 sc0
    s_mov_b64 exec, -1
    s_mov_b64 exec, 1
    buffer_atomic_add v2, off, s[48:51], s20 offset:384
    s_mov_b64 exec, -1
    v_mfma_f32_32x32x16_bf16 v[112:127], a[4:7], a[188:191], v[112:127]
    s_add_u32 m0, s64, 0x22000
    ds_read_b64_tr_b16 a[0:1], v14 offset:20480
    ds_read_b64_tr_b16 a[2:3], v14 offset:21504
    buffer_load_dwordx4 v140, s[40:43], s25 offen lds
    v_mfma_f32_32x32x16_bf16 v[96:111], a[8:11], a[192:195], v[96:111]
    s_add_u32 m0, s64, 0x23000
    ds_read_b64_tr_b16 a[4:5], v15 offset:20480
    ds_read_b64_tr_b16 a[6:7], v15 offset:21504
    buffer_load_dwordx4 v141, s[40:43], s25 offen lds
    v_mfma_f32_32x32x16_bf16 v[112:127], a[12:15], a[192:195], v[112:127]
    ds_read_b64_tr_b16 a[8:9], v14 offset:24576
    ds_read_b64_tr_b16 a[10:11], v14 offset:25600
    s_waitcnt lgkmcnt(6)
    v_mfma_f32_32x32x16_bf16 v[96:111], a[16:19], a[196:199], v[96:111]
    s_add_u32 m0, s64, 0x24000
    ds_read_b64_tr_b16 a[12:13], v15 offset:24576
    ds_read_b64_tr_b16 a[14:15], v15 offset:25600
    buffer_load_dwordx4 v140, s[40:43], s26 offen lds
    v_mfma_f32_32x32x16_bf16 v[112:127], a[20:23], a[196:199], v[112:127]
    s_add_u32 m0, s64, 0x25000
    ds_read_b64_tr_b16 a[16:17], v14 offset:28672
    ds_read_b64_tr_b16 a[18:19], v14 offset:29696
    buffer_load_dwordx4 v141, s[40:43], s26 offen lds
    v_mfma_f32_32x32x16_bf16 v[96:111], a[24:27], a[200:203], v[96:111]
    ds_read_b64_tr_b16 a[20:21], v15 offset:28672
    ds_read_b64_tr_b16 a[22:23], v15 offset:29696
    v_mfma_f32_32x32x16_bf16 v[112:127], a[28:31], a[200:203], v[112:127]
    s_barrier
    s_add_u32 m0, s64, 0x26000
    ds_read_b64_tr_b16 a[24:25], v14 offset:32768
    ds_read_b64_tr_b16 a[26:27], v14 offset:33792
    buffer_load_dwordx4 v140, s[40:43], s27 offen lds
    s_waitcnt lgkmcnt(6)
    v_mfma_f32_32x32x16_bf16 v[96:111], a[0:3], a[204:207], v[96:111]
    s_add_u32 m0, s64, 0x27000
    ds_read_b64_tr_b16 a[28:29], v15 offset:32768
    ds_read_b64_tr_b16 a[30:31], v15 offset:33792
    buffer_load_dwordx4 v141, s[40:43], s27 offen lds
    v_mfma_f32_32x32x16_bf16 v[112:127], a[4:7], a[204:207], v[112:127]
    s_add_u32 m0, s64, 0xe000
    ds_read_b64_tr_b16 a[0:1], v14 offset:36864
    ds_read_b64_tr_b16 a[2:3], v14 offset:37888
    buffer_load_dwordx4 v140, s[40:43], s32 offen lds
    v_mfma_f32_32x32x16_bf16 v[96:111], a[8:11], a[208:211], v[96:111]
    ds_read_b64_tr_b16 a[4:5], v15 offset:36864
    ds_read_b64_tr_b16 a[6:7], v15 offset:37888
    v_mfma_f32_32x32x16_bf16 v[112:127], a[12:15], a[208:211], v[112:127]
    s_add_u32 m0, s64, 0xf000
    ds_read_b64_tr_b16 a[8:9], v14 offset:40960
    ds_read_b64_tr_b16 a[10:11], v14 offset:41984
    buffer_load_dwordx4 v141, s[40:43], s32 offen lds
    s_waitcnt lgkmcnt(6)
    v_mfma_f32_32x32x16_bf16 v[96:111], a[16:19], a[212:215], v[96:111]
    s_add_u32 m0, s64, 0x10000
    ds_read_b64_tr_b16 a[12:13], v15 offset:40960
    ds_read_b64_tr_b16 a[14:15], v15 offset:41984
    buffer_load_dwordx4 v140, s[40:43], s33 offen lds
    v_mfma_f32_32x32x16_bf16 v[112:127], a[20:23], a[212:215], v[112:127]
    s_add_u32 m0, s64, 0x11000
    ds_read_b64_tr_b16 a[16:17], v14 offset:45056
    ds_read_b64_tr_b16 a[18:19], v14 offset:46080
    buffer_load_dwordx4 v141, s[40:43], s33 offen lds
    v_mfma_f32_32x32x16_bf16 v[96:111], a[24:27], a[216:219], v[96:111]
    ds_read_b64_tr_b16 a[20:21], v15 offset:45056
    ds_read_b64_tr_b16 a[22:23], v15 offset:46080
    v_mfma_f32_32x32x16_bf16 v[112:127], a[28:31], a[216:219], v[112:127]
    s_add_u32 m0, s64, 0x12000
    ds_read_b64_tr_b16 a[24:25], v14 offset:49152
    ds_read_b64_tr_b16 a[26:27], v14 offset:50176
    buffer_load_dwordx4 v140, s[40:43], s34 offen lds
    s_waitcnt lgkmcnt(6)
    v_mfma_f32_32x32x16_bf16 v[96:111], a[0:3], a[220:223], v[96:111]
    s_add_u32 m0, s64, 0x13000
    ds_read_b64_tr_b16 a[28:29], v15 offset:49152
    ds_read_b64_tr_b16 a[30:31], v15 offset:50176
    buffer_load_dwordx4 v141, s[40:43], s34 offen lds
    v_mfma_f32_32x32x16_bf16 v[112:127], a[4:7], a[220:223], v[112:127]
    ds_read_b64_tr_b16 a[0:1], v14 offset:53248
    ds_read_b64_tr_b16 a[2:3], v14 offset:54272
    v_mfma_f32_32x32x16_bf16 v[96:111], a[8:11], a[224:227], v[96:111]
    s_add_u32 m0, s64, 0x14000
    ds_read_b64_tr_b16 a[4:5], v15 offset:53248
    ds_read_b64_tr_b16 a[6:7], v15 offset:54272
    buffer_load_dwordx4 v142, s[40:43], s24 offen lds
    v_mfma_f32_32x32x16_bf16 v[112:127], a[12:15], a[224:227], v[112:127]
    s_add_u32 m0, s64, 0x0
    v_add_u32 v14, 61440, v14
    ds_read_b64_tr_b16 a[8:9], v14 offset:24576
    ds_read_b64_tr_b16 a[10:11], v14 offset:25600
    buffer_load_dwordx4 v143, s[40:43], s24 offen lds
    s_waitcnt lgkmcnt(6)
    v_mfma_f32_32x32x16_bf16 v[96:111], a[16:19], a[228:231], v[96:111]
    s_add_u32 m0, s64, 0x1000
    v_add_u32 v15, 61440, v15
    ds_read_b64_tr_b16 a[12:13], v15 offset:24576
    ds_read_b64_tr_b16 a[14:15], v15 offset:25600
    buffer_load_dwordx4 v142, s[40:43], s25 offen lds
    v_mfma_f32_32x32x16_bf16 v[112:127], a[20:23], a[228:231], v[112:127]
    ds_read_b64_tr_b16 a[16:17], v14 offset:28672
    ds_read_b64_tr_b16 a[18:19], v14 offset:29696
    v_mfma_f32_32x32x16_bf16 v[96:111], a[24:27], a[232:235], v[96:111]
    s_add_u32 m0, s64, 0x2000
    ds_read_b64_tr_b16 a[20:21], v15 offset:28672
    ds_read_b64_tr_b16 a[22:23], v15 offset:29696
    buffer_load_dwordx4 v143, s[40:43], s25 offen lds
    v_mfma_f32_32x32x16_bf16 v[112:127], a[28:31], a[232:235], v[112:127]
    s_barrier
    s_add_u32 m0, s64, 0x3000
    ds_read_b64_tr_b16 a[24:25], v14 offset:32768
    ds_read_b64_tr_b16 a[26:27], v14 offset:33792
    buffer_load_dwordx4 v142, s[40:43], s26 offen lds
    s_waitcnt lgkmcnt(6)
    v_mfma_f32_32x32x16_bf16 v[96:111], a[0:3], a[236:239], v[96:111]
    ds_read_b64_tr_b16 a[28:29], v15 offset:32768
    ds_read_b64_tr_b16 a[30:31], v15 offset:33792
    v_mfma_f32_32x32x16_bf16 v[112:127], a[4:7], a[236:239], v[112:127]
    s_add_u32 m0, s64, 0x4000
    ds_read_b64_tr_b16 a[0:1], v14 offset:36864
    ds_read_b64_tr_b16 a[2:3], v14 offset:37888
    buffer_load_dwordx4 v143, s[40:43], s26 offen lds
    v_mfma_f32_32x32x16_bf16 v[96:111], a[8:11], a[240:243], v[96:111]
    ds_read_b64_tr_b16 a[4:5], v15 offset:36864
    ds_read_b64_tr_b16 a[6:7], v15 offset:37888
    s_waitcnt vmcnt(19)
    v_readfirstlane_b32 s3, v3
    s_nop 0
    s_cmp_ge_u32 s3, 7
    s_cbranch_scc1 L_ok7
    s_mov_b32 s58, 100000
L_spin7:
    s_mov_b64 exec, 1
    buffer_atomic_umax v3, off, s[48:51], s59 sc0
    s_mov_b64 exec, -1
    s_waitcnt vmcnt(0)
    v_readfirstlane_b32 s3, v3
    s_nop 0
    s_cmp_ge_u32 s3, 7
    s_cbranch_scc1 L_ok7
    s_sub_u32 s58, s58, 1
    s_cmp_lg_u32 s58, 0
    s_cbranch_scc1 L_spin7
L_ok7:
    buffer_load_dwordx4 a[40:43], v144, s[48:51], s0 offen sc1
    v_mfma_f32_32x32x16_bf16 v[112:127], a[12:15], a[240:243], v[112:127]
    ds_read_b64_tr_b16 a[8:9], v14 offset:40960
    ds_read_b64_tr_b16 a[10:11], v14 offset:41984
    buffer_load_dwordx4 a[44:47], v144, s[48:51], s0 offen offset:1024 sc1
    s_waitcnt lgkmcnt(6)
    v_mfma_f32_32x32x16_bf16 v[96:111], a[16:19], a[244:247], v[96:111]
    ds_read_b64_tr_b16 a[12:13], v15 offset:40960
    ds_read_b64_tr_b16 a[14:15], v15 offset:41984
    v_mfma_f32_32x32x16_bf16 v[112:127], a[20:23], a[244:247], v[112:127]
    ds_read_b64_tr_b16 a[16:17], v14 offset:45056
    ds_read_b64_tr_b16 a[18:19], v14 offset:46080
    buffer_load_dwordx4 a[48:51], v144, s[48:51], s1 offen sc1
    v_mfma_f32_32x32x16_bf16 v[96:111], a[24:27], a[248:251], v[96:111]
    ds_read_b64_tr_b16 a[20:21], v15 offset:45056
    ds_read_b64_tr_b16 a[22:23], v15 offset:46080
    buffer_load_dwordx4 a[52:55], v144, s[48:51], s1 offen offset:1024 sc1
    v_mfma_f32_32x32x16_bf16 v[112:127], a[28:31], a[248:251], v[112:127]
    ds_read_b64_tr_b16 a[24:25], v14 offset:49152
    ds_read_b64_tr_b16 a[26:27], v14 offset:50176
    s_waitcnt lgkmcnt(6)
    v_mfma_f32_32x32x16_bf16 v[96:111], a[0:3], a[252:255], v[96:111]
    ds_read_b64_tr_b16 a[28:29], v15 offset:49152
    ds_read_b64_tr_b16 a[30:31], v15 offset:50176
    buffer_load_dwordx4 a[56:59], v144, s[48:51], s16 offen sc1
    v_mfma_f32_32x32x16_bf16 v[112:127], a[4:7], a[252:255], v[112:127]
    ds_read_b64_tr_b16 a[0:1], v14 offset:53248
    ds_read_b64_tr_b16 a[2:3], v14 offset:54272
    buffer_load_dwordx4 a[60:63], v144, s[48:51], s16 offen offset:1024 sc1
    v_mfma_f32_32x32x16_bf16 v[96:111], a[8:11], v[172:175], v[96:111]
    ds_read_b64_tr_b16 a[4:5], v15 offset:53248
    ds_read_b64_tr_b16 a[6:7], v15 offset:54272
    buffer_load_dwordx4 a[64:67], v144, s[48:51], s17 offen sc1
    v_mfma_f32_32x32x16_bf16 v[112:127], a[12:15], v[172:175], v[112:127]
    ds_read_b64_tr_b16 a[8:9], v14 offset:57344
    ds_read_b64_tr_b16 a[10:11], v14 offset:58368
    s_waitcnt lgkmcnt(6)
    v_mfma_f32_32x32x16_bf16 v[96:111], a[16:19], v[176:179], v[96:111]
    ds_read_b64_tr_b16 a[12:13], v15 offset:57344
    ds_read_b64_tr_b16 a[14:15], v15 offset:58368
    buffer_load_dwordx4 a[68:71], v144, s[48:51], s17 offen offset:1024 sc1
    v_mfma_f32_32x32x16_bf16 v[112:127], a[20:23], v[176:179], v[112:127]
    s_waitcnt vmcnt(23)
    s_barrier
    v_add_u32 v14, 61440, v14
    ds_read_b64_tr_b16 a[16:17], v14 offset:0
    ds_read_b64_tr_b16 a[18:19], v14 offset:1024
    buffer_load_dwordx4 a[72:75], v144, s[48:51], s19 offen sc1
    v_mfma_f32_32x32x16_bf16 v[96:111], a[24:27], v[180:183], v[96:111]
    v_add_u32 v15, 61440, v15
    ds_read_b64_tr_b16 a[20:21], v15 offset:0
    ds_read_b64_tr_b16 a[22:23], v15 offset:1024
    v_mfma_f32_32x32x16_bf16 v[112:127], a[28:31], v[180:183], v[112:127]
    ds_read_b64_tr_b16 a[24:25], v14 offset:4096
    ds_read_b64_tr_b16 a[26:27], v14 offset:5120
    buffer_load_dwordx4 a[76:79], v144, s[48:51], s19 offen offset:1024 sc1
    s_waitcnt lgkmcnt(6)
    v_mfma_f32_32x32x16_bf16 v[96:111], a[0:3], v[184:187], v[96:111]
    ds_read_b64_tr_b16 a[28:29], v15 offset:4096
    ds_read_b64_tr_b16 a[30:31], v15 offset:5120
    s_add_u32 s59, s21, 384
    v_mov_b32 v3, 0
    s_mov_b64 exec, 1
    buffer_atomic_umax v3, off, s[48:51], s59 sc0
    s_mov_b64 exec, -1
    v_mfma_f32_32x32x16_bf16 v[112:127], a[4:7], v[184:187], v[112:127]
    ds_read_b64_tr_b16 a[0:1], v14 offset:8192
    ds_read_b64_tr_b16 a[2:3], v14 offset:9216
    buffer_load_dwordx4 a[80:83], v144, s[48:51], s23 offen sc1
    v_mfma_f32_32x32x16_bf16 v[96:111], a[8:11], v[188:191], v[96:111]
    ds_read_b64_tr_b16 a[4:5], v15 offset:8192
    ds_read_b64_tr_b16 a[6:7], v15 offset:9216
    v_mfma_f32_32x32x16_bf16 v[112:127], a[12:15], v[188:191], v[112:127]
    ds_read_b64_tr_b16 a[8:9], v14 offset:12288
    ds_read_b64_tr_b16 a[10:11], v14 offset:13312
    buffer_load_dwordx4 a[84:87], v144, s[48:51], s23 offen offset:1024 sc1
    s_waitcnt lgkmcnt(6)
    v_mfma_f32_32x32x16_bf16 v[96:111], a[16:19], v[192:195], v[96:111]
    ds_read_b64_tr_b16 a[12:13], v15 offset:12288
    ds_read_b64_tr_b16 a[14:15], v15 offset:13312
    buffer_load_dwordx4 a[88:91], v144, s[48:51], s55 offen sc1
    v_mfma_f32_32x32x16_bf16 v[112:127], a[20:23], v[192:195], v[112:127]
    ds_read_b64_tr_b16 a[16:17], v14 offset:16384
    ds_read_b64_tr_b16 a[18:19], v14 offset:17408
    v_mfma_f32_32x32x16_bf16 v[96:111], a[24:27], v[196:199], v[96:111]
    ds_read_b64_tr_b16 a[20:21], v15 offset:16384
    ds_read_b64_tr_b16 a[22:23], v15 offset:17408
    buffer_load_dwordx4 a[92:95], v144, s[48:51], s55 offen offset:1024 sc1
    v_mfma_f32_32x32x16_bf16 v[112:127], a[28:31], v[196:199], v[112:127]
    s_add_u32 m0, s64, 0x5000
    ds_read_b64_tr_b16 a[24:25], v14 offset:20480
    ds_read_b64_tr_b16 a[26:27], v14 offset:21504
    buffer_load_dwordx4 v142, s[40:43], s27 offen lds
    s_waitcnt vmcnt(15) lgkmcnt(6)
    v_mfma_f32_32x32x16_bf16 v[96:111], a[0:3], a[40:43], v[96:111]
    s_add_u32 m0, s64, 0x6000
    ds_read_b64_tr_b16 a[28:29], v15 offset:20480
    ds_read_b64_tr_b16 a[30:31], v15 offset:21504
    buffer_load_dwordx4 v143, s[40:43], s27 offen lds
    v_mfma_f32_32x32x16_bf16 v[112:127], a[4:7], a[40:43], v[112:127]
    ds_read_b64_tr_b16 a[0:1], v14 offset:24576
    ds_read_b64_tr_b16 a[2:3], v14 offset:25600
    s_waitcnt vmcnt(15)
    v_mfma_f32_32x32x16_bf16 v[96:111], a[8:11], a[44:47], v[96:111]
    s_add_u32 m0, s64, 0x7000
    ds_read_b64_tr_b16 a[4:5], v15 offset:24576
    ds_read_b64_tr_b16 a[6:7], v15 offset:25600
    buffer_load_dwordx4 v142, s[40:43], s32 offen lds
    v_mfma_f32_32x32x16_bf16 v[112:127], a[12:15], a[44:47], v[112:127]
    s_add_u32 m0, s64, 0x8000
    s_barrier
    ds_read_b64_tr_b16 a[8:9], v14 offset:28672
    ds_read_b64_tr_b16 a[10:11], v14 offset:29696
    buffer_load_dwordx4 v143, s[40:43], s32 offen lds
    s_waitcnt vmcnt(16) lgkmcnt(6)
    v_mfma_f32_32x32x16_bf16 v[96:111], a[16:19], a[48:51], v[96:111]
    ds_read_b64_tr_b16 a[12:13], v15 offset:28672
    ds_read_b64_tr_b16 a[14:15], v15 offset:29696
    v_mfma_f32_32x32x16_bf16 v[112:127], a[20:23], a[48:51], v[112:127]
    s_add_u32 m0, s64, 0x9000
    ds_read_b64_tr_b16 a[16:17], v14 offset:32768
    ds_read_b64_tr_b16 a[18:19], v14 offset:33792
    buffer_load_dwordx4 v142, s[40:43], s33 offen lds
    s_waitcnt vmcnt(16)
    v_mfma_f32_32x32x16_bf16 v[96:111], a[24:27], a[52:55], v[96:111]
    s_add_u32 m0, s64, 0xa000
    ds_read_b64_tr_b16 a[20:21], v15 offset:32768
    ds_read_b64_tr_b16 a[22:23], v15 offset:33792
    buffer_load_dwordx4 v143, s[40:43], s33 offen lds
    v_mfma_f32_32x32x16_bf16 v[112:127], a[28:31], a[52:55], v[112:127]
    s_add_u32 m0, s64, 0xb000
    ds_read_b64_tr_b16 a[24:25], v14 offset:36864
    ds_read_b64_tr_b16 a[26:27], v14 offset:37888
    buffer_load_dwordx4 v142, s[40:43], s34 offen lds
    s_waitcnt vmcnt(17) lgkmcnt(6)
    v_mfma_f32_32x32x16_bf16 v[96:111], a[0:3], a[56:59], v[96:111]
    ds_read_b64_tr_b16 a[28:29], v15 offset:36864
    ds_read_b64_tr_b16 a[30:31], v15 offset:37888
    v_mfma_f32_32x32x16_bf16 v[112:127], a[4:7], a[56:59], v[112:127]
    s_add_u32 m0, s64, 0xc000
    v_subrev_u32 v14, 122880, v14
    ds_read_b64_tr_b16 a[0:1], v14 offset:57344
    ds_read_b64_tr_b16 a[2:3], v14 offset:58368
    buffer_load_dwordx4 v143, s[40:43], s34 offen lds
    s_waitcnt vmcnt(17)
    v_mfma_f32_32x32x16_bf16 v[96:111], a[8:11], a[60:63], v[96:111]
    v_subrev_u32 v15, 122880, v15
    ds_read_b64_tr_b16 a[4:5], v15 offset:57344
    ds_read_b64_tr_b16 a[6:7], v15 offset:58368
    s_waitcnt vmcnt(12)
    v_readfirstlane_b32 s3, v3
    s_nop 0
    s_cmp_ge_u32 s3, 7
    s_cbranch_scc1 L_ok8
    s_mov_b32 s58, 100000
L_spin8:
    s_mov_b64 exec, 1
    buffer_atomic_umax v3, off, s[48:51], s59 sc0
    s_mov_b64 exec, -1
    s_waitcnt vmcnt(0)
    v_readfirstlane_b32 s3, v3
    s_nop 0
    s_cmp_ge_u32 s3, 7
    s_cbranch_scc1 L_ok8
    s_sub_u32 s58, s58, 1
    s_cmp_lg_u32 s58, 0
    s_cbranch_scc1 L_spin8
L_ok8:
    buffer_load_dwordx4 a[96:99], v144, s[48:51], s0 offen offset:2048 sc1
    v_mfma_f32_32x32x16_bf16 v[112:127], a[12:15], a[60:63], v[112:127]
    v_add_u32 v14, 61440, v14
    ds_read_b64_tr_b16 a[8:9], v14 offset:0
    ds_read_b64_tr_b16 a[10:11], v14 offset:1024
    s_waitcnt lgkmcnt(6)
    v_mfma_f32_32x32x16_bf16 v[96:111], a[16:19], a[64:67], v[96:111]
    v_add_u32 v15, 61440, v15
    ds_read_b64_tr_b16 a[12:13], v15 offset:0
    ds_read_b64_tr_b16 a[14:15], v15 offset:1024
    buffer_load_dwordx4 a[100:103], v144, s[48:51], s0 offen offset:3072 sc1
    v_mfma_f32_32x32x16_bf16 v[112:127], a[20:23], a[64:67], v[112:127]
    ds_read_b64_tr_b16 a[16:17], v14 offset:4096
    ds_read_b64_tr_b16 a[18:19], v14 offset:5120
    buffer_load_dwordx4 a[104:107], v144, s[48:51], s1 offen offset:2048 sc1
    v_mfma_f32_32x32x16_bf16 v[96:111], a[24:27], a[68:71], v[96:111]
    ds_read_b64_tr_b16 a[20:21], v15 offset:4096
    ds_read_b64_tr_b16 a[22:23], v15 offset:5120
    buffer_load_dwordx4 a[108:111], v144, s[48:51], s1 offen offset:3072 sc1
    v_mfma_f32_32x32x16_bf16 v[112:127], a[28:31], a[68:71], v[112:127]
    ds_read_b64_tr_b16 a[24:25], v14 offset:8192
    ds_read_b64_tr_b16 a[26:27], v14 offset:9216
    s_waitcnt lgkmcnt(6)
    v_mfma_f32_32x32x16_bf16 v[96:111], a[0:3], a[72:75], v[96:111]
    ds_read_b64_tr_b16 a[28:29], v15 offset:8192
    ds_read_b64_tr_b16 a[30:31], v15 offset:9216
    buffer_load_dwordx4 a[112:115], v144, s[48:51], s16 offen offset:2048 sc1
    v_mfma_f32_32x32x16_bf16 v[112:127], a[4:7], a[72:75], v[112:127]
    s_barrier
    ds_read_b64_tr_b16 a[0:1], v14 offset:12288
    ds_read_b64_tr_b16 a[2:3], v14 offset:13312
    buffer_load_dwordx4 a[116:119], v144, s[48:51], s16 offen offset:3072 sc1
    v_mfma_f32_32x32x16_bf16 v[96:111], a[8:11], a[76:79], v[96:111]
    ds_read_b64_tr_b16 a[4:5], v15 offset:12288
    ds_read_b64_tr_b16 a[6:7], v15 offset:13312
    v_mfma_f32_32x32x16_bf16 v[112:127], a[12:15], a[76:79], v[112:127]
    ds_read_b64_tr_b16 a[8:9], v14 offset:16384
    ds_read_b64_tr_b16 a[10:11], v14 offset:17408
    buffer_load_dwordx4 a[120:123], v144, s[48:51], s17 offen offset:2048 sc1
    s_waitcnt vmcnt(18) lgkmcnt(6)
    v_mfma_f32_32x32x16_bf16 v[96:111], a[16:19], a[80:83], v[96:111]
    ds_read_b64_tr_b16 a[12:13], v15 offset:16384
    ds_read_b64_tr_b16 a[14:15], v15 offset:17408
    buffer_load_dwordx4 a[124:127], v144, s[48:51], s17 offen offset:3072 sc1
    v_mfma_f32_32x32x16_bf16 v[112:127], a[20:23], a[80:83], v[112:127]
    ds_read_b64_tr_b16 a[16:17], v14 offset:20480
    ds_read_b64_tr_b16 a[18:19], v14 offset:21504
    s_waitcnt vmcnt(18)
    v_mfma_f32_32x32x16_bf16 v[96:111], a[24:27], a[84:87], v[96:111]
    ds_read_b64_tr_b16 a[20:21], v15 offset:20480
    ds_read_b64_tr_b16 a[22:23], v15 offset:21504
    buffer_load_dwordx4 a[128:131], v144, s[48:51], s19 offen offset:2048 sc1
    v_mfma_f32_32x32x16_bf16 v[112:127], a[28:31], a[84:87], v[112:127]
    v_subrev_u32 v14, 61440, v14
    ds_read_b64_tr_b16 a[24:25], v14 offset:0
    ds_read_b64_tr_b16 a[26:27], v14 offset:1024
    buffer_load_dwordx4 a[132:135], v144, s[48:51], s19 offen offset:3072 sc1
    s_waitcnt vmcnt(19) lgkmcnt(6)
    v_mfma_f32_32x32x16_bf16 v[96:111], a[0:3], a[88:91], v[96:111]
    v_subrev_u32 v15, 61440, v15
    ds_read_b64_tr_b16 a[28:29], v15 offset:0
    ds_read_b64_tr_b16 a[30:31], v15 offset:1024
    buffer_load_dwordx4 a[136:139], v144, s[48:51], s23 offen offset:2048 sc1
    v_mfma_f32_32x32x16_bf16 v[112:127], a[4:7], a[88:91], v[112:127]
    ds_read_b64_tr_b16 a[0:1], v14 offset:4096
    ds_read_b64_tr_b16 a[2:3], v14 offset:5120
    s_waitcnt vmcnt(19)
    v_mfma_f32_32x32x16_bf16 v[96:111], a[8:11], a[92:95], v[96:111]
    ds_read_b64_tr_b16 a[4:5], v15 offset:4096
    ds_read_b64_tr_b16 a[6:7], v15 offset:5120
    buffer_load_dwordx4 a[140:143], v144, s[48:51], s23 offen offset:3072 sc1
    v_mfma_f32_32x32x16_bf16 v[112:127], a[12:15], a[92:95], v[112:127]
    ds_read_b64_tr_b16 a[8:9], v14 offset:8192
    ds_read_b64_tr_b16 a[10:11], v14 offset:9216
    buffer_load_dwordx4 a[144:147], v144, s[48:51], s55 offen offset:2048 sc1
    s_waitcnt vmcnt(12) lgkmcnt(6)
    v_mfma_f32_32x32x16_bf16 v[96:111], a[16:19], a[96:99], v[96:111]
    ds_read_b64_tr_b16 a[12:13], v15 offset:8192
    ds_read_b64_tr_b16 a[14:15], v15 offset:9216
    v_mfma_f32_32x32x16_bf16 v[112:127], a[20:23], a[96:99], v[112:127]
    ds_read_b64_tr_b16 a[16:17], v14 offset:12288
    ds_read_b64_tr_b16 a[18:19], v14 offset:13312
    buffer_load_dwordx4 a[148:151], v144, s[48:51], s55 offen offset:3072 sc1
    s_waitcnt vmcnt(12)
    v_mfma_f32_32x32x16_bf16 v[96:111], a[24:27], a[100:103], v[96:111]
    ds_read_b64_tr_b16 a[20:21], v15 offset:12288
    ds_read_b64_tr_b16 a[22:23], v15 offset:13312
    v_mfma_f32_32x32x16_bf16 v[112:127], a[28:31], a[100:103], v[112:127]
    ds_read_b64_tr_b16 a[24:25], v14 offset:16384
    ds_read_b64_tr_b16 a[26:27], v14 offset:17408
    s_waitcnt vmcnt(11) lgkmcnt(6)
    v_mfma_f32_32x32x16_bf16 v[96:111], a[0:3], a[104:107], v[96:111]
    ds_read_b64_tr_b16 a[28:29], v15 offset:16384
    ds_read_b64_tr_b16 a[30:31], v15 offset:17408
    v_mfma_f32_32x32x16_bf16 v[112:127], a[4:7], a[104:107], v[112:127]
    s_barrier
    ds_read_b64_tr_b16 a[0:1], v14 offset:20480
    ds_read_b64_tr_b16 a[2:3], v14 offset:21504
    s_waitcnt vmcnt(10)
    v_mfma_f32_32x32x16_bf16 v[96:111], a[8:11], a[108:111], v[96:111]
    ds_read_b64_tr_b16 a[4:5], v15 offset:20480
    ds_read_b64_tr_b16 a[6:7], v15 offset:21504
    v_mfma_f32_32x32x16_bf16 v[112:127], a[12:15], a[108:111], v[112:127]
    ds_read_b64_tr_b16 a[8:9], v14 offset:24576
    ds_read_b64_tr_b16 a[10:11], v14 offset:25600
    s_waitcnt vmcnt(9) lgkmcnt(6)
    v_mfma_f32_32x32x16_bf16 v[96:111], a[16:19], a[112:115], v[96:111]
    ds_read_b64_tr_b16 a[12:13], v15 offset:24576
    ds_read_b64_tr_b16 a[14:15], v15 offset:25600
    v_and_b32 v28, 31, v0
    v_lshrrev_b32 v29, 5, v0
    s_lshl_b32 s3, s68, 2
    v_add_u32 v29, s3, v29
    v_xor_b32 v29, v29, v28
    v_and_b32 v29, 7, v29
    v_lshlrev_b32 v28, 7, v28
    v_lshl_add_u32 v28, v29, 4, v28
    s_lshl_b32 s3, s67, 12
    s_add_u32 s3, s3, 69632
    v_add_u32 v240, s3, v28
    v_xor_b32 v241, 32, v240
    v_mfma_f32_32x32x16_bf16 v[112:127], a[20:23], a[112:115], v[112:127]
    ds_read_b64_tr_b16 a[16:17], v14 offset:28672
    ds_read_b64_tr_b16 a[18:19], v14 offset:29696
    s_waitcnt vmcnt(8)
    v_mfma_f32_32x32x16_bf16 v[96:111], a[24:27], a[116:119], v[96:111]
    ds_read_b64_tr_b16 a[20:21], v15 offset:28672
    ds_read_b64_tr_b16 a[22:23], v15 offset:29696
    v_lshrrev_b32 v28, 3, v0
    v_xor_b32 v29, v28, v0
    v_and_b32 v29, 7, v29
    v_lshlrev_b32 v29, 4, v29
    v_lshl_add_u32 v29, v28, 7, v29
    s_lshl_b32 s3, s62, 11
    s_add_u32 s3, s3, 69632
    v_add_u32 v242, s3, v29
    v_mul_u32_u24 v28, 896, v28
    v_and_b32 v29, 7, v0
    v_lshl_add_u32 v28, v29, 4, v28
    s_lshl1_add_u32 s3, s60, s65
    s_lshl2_add_u32 s3, s3, s62
    s_mul_i32 s3, s3, 14336
    s_lshl_b32 s4, s63, 7
    s_add_u32 s57, s3, s4
    s_add_u32 s56, s57, 7168
    v_mfma_f32_32x32x16_bf16 v[112:127], a[28:31], a[116:119], v[112:127]
    s_barrier
    ds_read_b64_tr_b16 a[24:25], v14 offset:32768
    ds_read_b64_tr_b16 a[26:27], v14 offset:33792
    s_waitcnt vmcnt(7) lgkmcnt(6)
    v_mfma_f32_32x32x16_bf16 v[96:111], a[0:3], a[120:123], v[96:111]
    ds_read_b64_tr_b16 a[28:29], v15 offset:32768
    ds_read_b64_tr_b16 a[30:31], v15 offset:33792
    s_lshl_b32 s3, s62, 12
    s_xor_b32 s4, s3, 8192
    s_add_u32 s3, s3, 53248
    s_add_u32 s4, s4, 53248
    v_add_u32 v26, s3, v1
    v_add_u32 v27, s4, v1
    v_mfma_f32_32x32x16_bf16 v[112:127], a[4:7], a[120:123], v[112:127]
    ds_read_b64_tr_b16 a[0:1], v15 offset:36864
    ds_read_b64_tr_b16 a[2:3], v15 offset:37888
    s_waitcnt vmcnt(6)
    v_mfma_f32_32x32x16_bf16 v[96:111], a[8:11], a[124:127], v[96:111]
    ds_read_b64_tr_b16 a[4:5], v15 offset:40960
    ds_read_b64_tr_b16 a[6:7], v15 offset:41984
    v_mfma_f32_32x32x16_bf16 v[112:127], a[12:15], a[124:127], v[112:127]
    ds_read_b64_tr_b16 a[8:9], v15 offset:45056
    ds_read_b64_tr_b16 a[10:11], v15 offset:46080
    s_waitcnt vmcnt(5) lgkmcnt(6)
    v_mfma_f32_32x32x16_bf16 v[96:111], a[16:19], a[128:131], v[96:111]
    ds_read_b64_tr_b16 a[12:13], v15 offset:49152
    ds_read_b64_tr_b16 a[14:15], v15 offset:50176
    v_mfma_f32_32x32x16_bf16 v[112:127], a[20:23], a[128:131], v[112:127]
    ds_read_b64_tr_b16 a[16:17], v14 offset:36864
    ds_read_b64_tr_b16 a[18:19], v14 offset:37888
    s_waitcnt vmcnt(4)
    v_mfma_f32_32x32x16_bf16 v[96:111], a[24:27], a[132:135], v[96:111]
    ds_read_b64_tr_b16 a[20:21], v14 offset:40960
    ds_read_b64_tr_b16 a[22:23], v14 offset:41984
    v_mfma_f32_32x32x16_bf16 v[112:127], a[28:31], a[132:135], v[112:127]
    ds_read_b64_tr_b16 a[24:25], v14 offset:45056
    ds_read_b64_tr_b16 a[26:27], v14 offset:46080
    s_waitcnt vmcnt(3) lgkmcnt(6)
    v_mfma_f32_32x32x16_bf16 v[112:127], a[0:3], a[136:139], v[112:127]
    ds_read_b64_tr_b16 a[28:29], v14 offset:49152
    ds_read_b64_tr_b16 a[30:31], v14 offset:50176
    s_waitcnt vmcnt(2)
    v_mfma_f32_32x32x16_bf16 v[112:127], a[4:7], a[140:143], v[112:127]
    s_waitcnt vmcnt(1)
    v_mfma_f32_32x32x16_bf16 v[112:127], a[8:11], a[144:147], v[112:127]
    s_waitcnt vmcnt(0)
    v_mfma_f32_32x32x16_bf16 v[112:127], a[12:15], a[148:151], v[112:127]
    s_waitcnt lgkmcnt(0)
    v_mfma_f32_32x32x16_bf16 v[96:111], a[16:19], a[136:139], v[96:111]
    v_mfma_f32_32x32x16_bf16 v[96:111], a[20:23], a[140:143], v[96:111]
    s_nop 8
    ds_write_b128 v26, v[112:115] offset:0
    ds_write_b128 v26, v[116:119] offset:1024
    ds_write_b128 v26, v[120:123] offset:2048
    ds_write_b128 v26, v[124:127] offset:3072
    v_mfma_f32_32x32x16_bf16 v[96:111], a[24:27], a[144:147], v[96:111]
    v_mfma_f32_32x32x16_bf16 v[96:111], a[28:31], a[148:151], v[96:111]
    s_waitcnt lgkmcnt(0)
    s_barrier
    ds_read_b128 v[64:67], v27 offset:0
    ds_read_b128 v[68:71], v27 offset:1024
    ds_read_b128 v[72:75], v27 offset:2048
    ds_read_b128 v[76:79], v27 offset:3072
    s_waitcnt lgkmcnt(3)
    s_nop 4
    v_pk_add_f32 v[96:97], v[96:97], v[64:65]
    v_pk_add_f32 v[98:99], v[98:99], v[66:67]
    s_waitcnt lgkmcnt(2)
    v_pk_add_f32 v[100:101], v[100:101], v[68:69]
    v_pk_add_f32 v[102:103], v[102:103], v[70:71]
    v_cvt_pk_bf16_f32 v32, v96, v97
    v_cvt_pk_bf16_f32 v33, v98, v99
    v_cvt_pk_bf16_f32 v34, v100, v101
    v_cvt_pk_bf16_f32 v35, v102, v103
    s_nop 0
    v_permlane32_swap_b32 v32, v34
    v_permlane32_swap_b32 v33, v35
    ds_write_b128 v240, v[32:35]
    s_waitcnt lgkmcnt(2)
    v_pk_add_f32 v[104:105], v[104:105], v[72:73]
    v_pk_add_f32 v[106:107], v[106:107], v[74:75]
    s_waitcnt lgkmcnt(1)
    v_pk_add_f32 v[108:109], v[108:109], v[76:77]
    v_pk_add_f32 v[110:111], v[110:111], v[78:79]
    v_cvt_pk_bf16_f32 v36, v104, v105
    v_cvt_pk_bf16_f32 v37, v106, v107
    v_cvt_pk_bf16_f32 v38, v108, v109
    v_cvt_pk_bf16_f32 v39, v110, v111
    s_nop 0
    v_permlane32_swap_b32 v36, v38
    v_permlane32_swap_b32 v37, v39
    ds_write_b128 v241, v[36:39]
    s_waitcnt lgkmcnt(0)
    s_barrier
    ds_read_b128 v[40:43], v242 offset:0
    ds_read_b128 v[44:47], v242 offset:1024
    s_waitcnt lgkmcnt(1)
    buffer_store_dwordx4 v[40:43], v28, s[44:47], s57 offen sc1
    s_waitcnt lgkmcnt(0)
    buffer_store_dwordx4 v[44:47], v28, s[44:47], s56 offen sc1
    s_branch L_fin
L_idle:
    s_lshl1_add_u32 s6, s60, s65
    s_cmp_lt_u32 s6, 28
    s_cselect_b32 s38, 1605632, 0
    s_mul_i32 s3, s67, 802816
    s_lshl_b32 s4, s6, 7
    s_add_u32 s56, s3, s4
    v_lshrrev_b32 v26, 3, v0
    v_mul_u32_u24 v26, 3584, v26
    v_and_b32 v27, 7, v0
    v_lshl_add_u32 v26, v27, 4, v26
    v_mov_b32 v240, 0x3f80
    v_mov_b32 v241, 0x3f800000
    buffer_load_dwordx4 v[128:131], v26, s[36:39], s56 offen
    s_add_u32 s56, s56, 28672
    s_waitcnt vmcnt(1)
    s_mov_b64 exec, 1
    buffer_atomic_add v2, off, s[48:51], s20
    s_mov_b64 exec, -1
    s_barrier
    s_cmp_ge_u32 s6, 28
    s_cbranch_scc1 L_idle2
    buffer_load_dwordx4 v[132:135], v26, s[36:39], s56 offen
    s_add_u32 s56, s56, 28672
    buffer_load_dwordx4 v[136:139], v26, s[36:39], s56 offen
    s_add_u32 s56, s56, 28672
    buffer_load_dwordx4 v[140:143], v26, s[36:39], s56 offen
    s_add_u32 s56, s56, 28672
    buffer_load_dwordx4 v[144:147], v26, s[36:39], s56 offen
    s_add_u32 s56, s56, 28672
    buffer_load_dwordx4 v[148:151], v26, s[36:39], s56 offen
    s_add_u32 s56, s56, 28672
    buffer_load_dwordx4 v[152:155], v26, s[36:39], s56 offen
    s_add_u32 s56, s56, 28672
    buffer_load_dwordx4 v[156:159], v26, s[36:39], s56 offen
    s_add_u32 s56, s56, 28672
    buffer_load_dwordx4 v[160:163], v26, s[36:39], s56 offen
    s_add_u32 s56, s56, 28672
    buffer_load_dwordx4 v[164:167], v26, s[36:39], s56 offen
    s_add_u32 s56, s56, 28672
    buffer_load_dwordx4 v[168:171], v26, s[36:39], s56 offen
    s_add_u32 s56, s56, 28672
    buffer_load_dwordx4 v[172:175], v26, s[36:39], s56 offen
    s_add_u32 s56, s56, 28672
    buffer_load_dwordx4 v[176:179], v26, s[36:39], s56 offen
    s_add_u32 s56, s56, 28672
    buffer_load_dwordx4 v[180:183], v26, s[36:39], s56 offen
    s_add_u32 s56, s56, 28672
    buffer_load_dwordx4 v[184:187], v26, s[36:39], s56 offen
    s_add_u32 s56, s56, 28672
    buffer_load_dwordx4 v[188:191], v26, s[36:39], s56 offen
    s_add_u32 s56, s56, 28672
    buffer_load_dwordx4 v[192:195], v26, s[36:39], s56 offen
    s_add_u32 s56, s56, 28672
    buffer_load_dwordx4 v[196:199], v26, s[36:39], s56 offen
    s_add_u32 s56, s56, 28672
    buffer_load_dwordx4 v[200:203], v26, s[36:39], s56 offen
    s_add_u32 s56, s56, 28672
    buffer_load_dwordx4 v[204:207], v26, s[36:39], s56 offen
    s_add_u32 s56, s56, 28672
    buffer_load_dwordx4 v[208:211], v26, s[36:39], s56 offen
    s_add_u32 s56, s56, 28672
    buffer_load_dwordx4 v[212:215], v26, s[36:39], s56 offen
    s_add_u32 s56, s56, 28672
    buffer_load_dwordx4 v[216:219], v26, s[36:39], s56 offen
    s_add_u32 s56, s56, 28672
    buffer_load_dwordx4 v[220:223], v26, s[36:39], s56 offen
    s_add_u32 s56, s56, 28672
    buffer_load_dwordx4 v[224:227], v26, s[36:39], s56 offen
    s_add_u32 s56, s56, 28672
    buffer_load_dwordx4 v[228:231], v26, s[36:39], s56 offen
    s_add_u32 s56, s56, 28672
    buffer_load_dwordx4 v[232:235], v26, s[36:39], s56 offen
    s_add_u32 s56, s56, 28672
    buffer_load_dwordx4 v[236:239], v26, s[36:39], s56 offen
    s_add_u32 s56, s56, 28672
    v_mov_b32 v32, 0
    v_mov_b32 v33, 0
    v_mov_b32 v34, 0
    v_mov_b32 v35, 0
    v_mov_b32 v36, 0
    v_mov_b32 v37, 0
    v_mov_b32 v38, 0
    v_mov_b32 v39, 0
    s_waitcnt vmcnt(28)
    v_dot2c_f32_bf16 v32, v128, v240
    v_dot2c_f32_bf16 v33, v128, v241
    v_dot2c_f32_bf16 v34, v129, v240
    v_dot2c_f32_bf16 v35, v129, v241
    v_dot2c_f32_bf16 v36, v130, v240
    v_dot2c_f32_bf16 v37, v130, v241
    v_dot2c_f32_bf16 v38, v131, v240
    v_dot2c_f32_bf16 v39, v131, v241
    s_waitcnt vmcnt(26)
    v_dot2c_f32_bf16 v32, v132, v240
    v_dot2c_f32_bf16 v33, v132, v241
    v_dot2c_f32_bf16 v34, v133, v240
    v_dot2c_f32_bf16 v35, v133, v241
    v_dot2c_f32_bf16 v36, v134, v240
    v_dot2c_f32_bf16 v37, v134, v241
    v_dot2c_f32_bf16 v38, v135, v240
    v_dot2c_f32_bf16 v39, v135, v241
    s_waitcnt vmcnt(25)
    v_dot2c_f32_bf16 v32, v136, v240
    v_dot2c_f32_bf16 v33, v136, v241
    v_dot2c_f32_bf16 v34, v137, v240
    v_dot2c_f32_bf16 v35, v137, v241
    v_dot2c_f32_bf16 v36, v138, v240
    v_dot2c_f32_bf16 v37, v138, v241
    v_dot2c_f32_bf16 v38, v139, v240
    v_dot2c_f32_bf16 v39, v139, v241
    s_waitcnt vmcnt(24)
    v_dot2c_f32_bf16 v32, v140, v240
    v_dot2c_f32_bf16 v33, v140, v241
    v_dot2c_f32_bf16 v34, v141, v240
    v_dot2c_f32_bf16 v35, v141, v241
    v_dot2c_f32_bf16 v36, v142, v240
    v_dot2c_f32_bf16 v37, v142, v241
    v_dot2c_f32_bf16 v38, v143, v240
    v_dot2c_f32_bf16 v39, v143, v241
    s_waitcnt vmcnt(23)
    v_dot2c_f32_bf16 v32, v144, v240
    v_dot2c_f32_bf16 v33, v144, v241
    v_dot2c_f32_bf16 v34, v145, v240
    v_dot2c_f32_bf16 v35, v145, v241
    v_dot2c_f32_bf16 v36, v146, v240
    v_dot2c_f32_bf16 v37, v146, v241
    v_dot2c_f32_bf16 v38, v147, v240
    v_dot2c_f32_bf16 v39, v147, v241
    s_waitcnt vmcnt(22)
    v_dot2c_f32_bf16 v32, v148, v240
    v_dot2c_f32_bf16 v33, v148, v241
    v_dot2c_f32_bf16 v34, v149, v240
    v_dot2c_f32_bf16 v35, v149, v241
    v_dot2c_f32_bf16 v36, v150, v240
    v_dot2c_f32_bf16 v37, v150, v241
    v_dot2c_f32_bf16 v38, v151, v240
    v_dot2c_f32_bf16 v39, v151, v241
    s_waitcnt vmcnt(21)
    v_dot2c_f32_bf16 v32, v152, v240
    v_dot2c_f32_bf16 v33, v152, v241
    v_dot2c_f32_bf16 v34, v153, v240
    v_dot2c_f32_bf16 v35, v153, v241
    v_dot2c_f32_bf16 v36, v154, v240
    v_dot2c_f32_bf16 v37, v154, v241
    v_dot2c_f32_bf16 v38, v155, v240
    v_dot2c_f32_bf16 v39, v155, v241
    s_waitcnt vmcnt(20)
    v_dot2c_f32_bf16 v32, v156, v240
    v_dot2c_f32_bf16 v33, v156, v241
    v_dot2c_f32_bf16 v34, v157, v240
    v_dot2c_f32_bf16 v35, v157, v241
    v_dot2c_f32_bf16 v36, v158, v240
    v_dot2c_f32_bf16 v37, v158, v241
    v_dot2c_f32_bf16 v38, v159, v240
    v_dot2c_f32_bf16 v39, v159, v241
    s_waitcnt vmcnt(19)
    v_dot2c_f32_bf16 v32, v160, v240
    v_dot2c_f32_bf16 v33, v160, v241
    v_dot2c_f32_bf16 v34, v161, v240
    v_dot2c_f32_bf16 v35, v161, v241
    v_dot2c_f32_bf16 v36, v162, v240
    v_dot2c_f32_bf16 v37, v162, v241
    v_dot2c_f32_bf16 v38, v163, v240
    v_dot2c_f32_bf16 v39, v163, v241
    s_waitcnt vmcnt(18)
    v_dot2c_f32_bf16 v32, v164, v240
    v_dot2c_f32_bf16 v33, v164, v241
    v_dot2c_f32_bf16 v34, v165, v240
    v_dot2c_f32_bf16 v35, v165, v241
    v_dot2c_f32_bf16 v36, v166, v240
    v_dot2c_f32_bf16 v37, v166, v241
    v_dot2c_f32_bf16 v38, v167, v240
    v_dot2c_f32_bf16 v39, v167, v241
    s_waitcnt vmcnt(17)
    v_dot2c_f32_bf16 v32, v168, v240
    v_dot2c_f32_bf16 v33, v168, v241
    v_dot2c_f32_bf16 v34, v169, v240
    v_dot2c_f32_bf16 v35, v169, v241
    v_dot2c_f32_bf16 v36, v170, v240
    v_dot2c_f32_bf16 v37, v170, v241
    v_dot2c_f32_bf16 v38, v171, v240
    v_dot2c_f32_bf16 v39, v171, v241
    s_waitcnt vmcnt(16)
    v_dot2c_f32_bf16 v32, v172, v240
    v_dot2c_f32_bf16 v33, v172, v241
    v_dot2c_f32_bf16 v34, v173, v240
    v_dot2c_f32_bf16 v35, v173, v241
    v_dot2c_f32_bf16 v36, v174, v240
    v_dot2c_f32_bf16 v37, v174, v241
    v_dot2c_f32_bf16 v38, v175, v240
    v_dot2c_f32_bf16 v39, v175, v241
    s_waitcnt vmcnt(15)
    v_dot2c_f32_bf16 v32, v176, v240
    v_dot2c_f32_bf16 v33, v176, v241
    v_dot2c_f32_bf16 v34, v177, v240
    v_dot2c_f32_bf16 v35, v177, v241
    v_dot2c_f32_bf16 v36, v178, v240
    v_dot2c_f32_bf16 v37, v178, v241
    v_dot2c_f32_bf16 v38, v179, v240
    v_dot2c_f32_bf16 v39, v179, v241
    s_waitcnt vmcnt(14)
    v_dot2c_f32_bf16 v32, v180, v240
    v_dot2c_f32_bf16 v33, v180, v241
    v_dot2c_f32_bf16 v34, v181, v240
    v_dot2c_f32_bf16 v35, v181, v241
    v_dot2c_f32_bf16 v36, v182, v240
    v_dot2c_f32_bf16 v37, v182, v241
    v_dot2c_f32_bf16 v38, v183, v240
    v_dot2c_f32_bf16 v39, v183, v241
    s_waitcnt vmcnt(13)
    v_dot2c_f32_bf16 v32, v184, v240
    v_dot2c_f32_bf16 v33, v184, v241
    v_dot2c_f32_bf16 v34, v185, v240
    v_dot2c_f32_bf16 v35, v185, v241
    v_dot2c_f32_bf16 v36, v186, v240
    v_dot2c_f32_bf16 v37, v186, v241
    v_dot2c_f32_bf16 v38, v187, v240
    v_dot2c_f32_bf16 v39, v187, v241
    s_waitcnt vmcnt(12)
    v_dot2c_f32_bf16 v32, v188, v240
    v_dot2c_f32_bf16 v33, v188, v241
    v_dot2c_f32_bf16 v34, v189, v240
    v_dot2c_f32_bf16 v35, v189, v241
    v_dot2c_f32_bf16 v36, v190, v240
    v_dot2c_f32_bf16 v37, v190, v241
    v_dot2c_f32_bf16 v38, v191, v240
    v_dot2c_f32_bf16 v39, v191, v241
    s_waitcnt vmcnt(11)
    v_dot2c_f32_bf16 v32, v192, v240
    v_dot2c_f32_bf16 v33, v192, v241
    v_dot2c_f32_bf16 v34, v193, v240
    v_dot2c_f32_bf16 v35, v193, v241
    v_dot2c_f32_bf16 v36, v194, v240
    v_dot2c_f32_bf16 v37, v194, v241
    v_dot2c_f32_bf16 v38, v195, v240
    v_dot2c_f32_bf16 v39, v195, v241
    s_waitcnt vmcnt(10)
    v_dot2c_f32_bf16 v32, v196, v240
    v_dot2c_f32_bf16 v33, v196, v241
    v_dot2c_f32_bf16 v34, v197, v240
    v_dot2c_f32_bf16 v35, v197, v241
    v_dot2c_f32_bf16 v36, v198, v240
    v_dot2c_f32_bf16 v37, v198, v241
    v_dot2c_f32_bf16 v38, v199, v240
    v_dot2c_f32_bf16 v39, v199, v241
    s_waitcnt vmcnt(9)
    v_dot2c_f32_bf16 v32, v200, v240
    v_dot2c_f32_bf16 v33, v200, v241
    v_dot2c_f32_bf16 v34, v201, v240
    v_dot2c_f32_bf16 v35, v201, v241
    v_dot2c_f32_bf16 v36, v202, v240
    v_dot2c_f32_bf16 v37, v202, v241
    v_dot2c_f32_bf16 v38, v203, v240
    v_dot2c_f32_bf16 v39, v203, v241
    s_waitcnt vmcnt(8)
    v_dot2c_f32_bf16 v32, v204, v240
    v_dot2c_f32_bf16 v33, v204, v241
    v_dot2c_f32_bf16 v34, v205, v240
    v_dot2c_f32_bf16 v35, v205, v241
    v_dot2c_f32_bf16 v36, v206, v240
    v_dot2c_f32_bf16 v37, v206, v241
    v_dot2c_f32_bf16 v38, v207, v240
    v_dot2c_f32_bf16 v39, v207, v241
    s_waitcnt vmcnt(7)
    v_dot2c_f32_bf16 v32, v208, v240
    v_dot2c_f32_bf16 v33, v208, v241
    v_dot2c_f32_bf16 v34, v209, v240
    v_dot2c_f32_bf16 v35, v209, v241
    v_dot2c_f32_bf16 v36, v210, v240
    v_dot2c_f32_bf16 v37, v210, v241
    v_dot2c_f32_bf16 v38, v211, v240
    v_dot2c_f32_bf16 v39, v211, v241
    s_waitcnt vmcnt(6)
    v_dot2c_f32_bf16 v32, v212, v240
    v_dot2c_f32_bf16 v33, v212, v241
    v_dot2c_f32_bf16 v34, v213, v240
    v_dot2c_f32_bf16 v35, v213, v241
    v_dot2c_f32_bf16 v36, v214, v240
    v_dot2c_f32_bf16 v37, v214, v241
    v_dot2c_f32_bf16 v38, v215, v240
    v_dot2c_f32_bf16 v39, v215, v241
    s_waitcnt vmcnt(5)
    v_dot2c_f32_bf16 v32, v216, v240
    v_dot2c_f32_bf16 v33, v216, v241
    v_dot2c_f32_bf16 v34, v217, v240
    v_dot2c_f32_bf16 v35, v217, v241
    v_dot2c_f32_bf16 v36, v218, v240
    v_dot2c_f32_bf16 v37, v218, v241
    v_dot2c_f32_bf16 v38, v219, v240
    v_dot2c_f32_bf16 v39, v219, v241
    s_waitcnt vmcnt(4)
    v_dot2c_f32_bf16 v32, v220, v240
    v_dot2c_f32_bf16 v33, v220, v241
    v_dot2c_f32_bf16 v34, v221, v240
    v_dot2c_f32_bf16 v35, v221, v241
    v_dot2c_f32_bf16 v36, v222, v240
    v_dot2c_f32_bf16 v37, v222, v241
    v_dot2c_f32_bf16 v38, v223, v240
    v_dot2c_f32_bf16 v39, v223, v241
    s_waitcnt vmcnt(3)
    v_dot2c_f32_bf16 v32, v224, v240
    v_dot2c_f32_bf16 v33, v224, v241
    v_dot2c_f32_bf16 v34, v225, v240
    v_dot2c_f32_bf16 v35, v225, v241
    v_dot2c_f32_bf16 v36, v226, v240
    v_dot2c_f32_bf16 v37, v226, v241
    v_dot2c_f32_bf16 v38, v227, v240
    v_dot2c_f32_bf16 v39, v227, v241
    s_waitcnt vmcnt(2)
    v_dot2c_f32_bf16 v32, v228, v240
    v_dot2c_f32_bf16 v33, v228, v241
    v_dot2c_f32_bf16 v34, v229, v240
    v_dot2c_f32_bf16 v35, v229, v241
    v_dot2c_f32_bf16 v36, v230, v240
    v_dot2c_f32_bf16 v37, v230, v241
    v_dot2c_f32_bf16 v38, v231, v240
    v_dot2c_f32_bf16 v39, v231, v241
    s_waitcnt vmcnt(1)
    v_dot2c_f32_bf16 v32, v232, v240
    v_dot2c_f32_bf16 v33, v232, v241
    v_dot2c_f32_bf16 v34, v233, v240
    v_dot2c_f32_bf16 v35, v233, v241
    v_dot2c_f32_bf16 v36, v234, v240
    v_dot2c_f32_bf16 v37, v234, v241
    v_dot2c_f32_bf16 v38, v235, v240
    v_dot2c_f32_bf16 v39, v235, v241
    s_waitcnt vmcnt(0)
    v_dot2c_f32_bf16 v32, v236, v240
    v_dot2c_f32_bf16 v33, v236, v241
    v_dot2c_f32_bf16 v34, v237, v240
    v_dot2c_f32_bf16 v35, v237, v241
    v_dot2c_f32_bf16 v36, v238, v240
    v_dot2c_f32_bf16 v37, v238, v241
    v_dot2c_f32_bf16 v38, v239, v240
    v_dot2c_f32_bf16 v39, v239, v241
    v_mov_b32 v40, v32
    v_mov_b32 v41, v33
    v_mov_b32 v42, v34
    v_mov_b32 v43, v35
    v_mov_b32 v44, v36
    v_mov_b32 v45, v37
    v_mov_b32 v46, v38
    v_mov_b32 v47, v39
    v_permlane32_swap_b32 v40, v32
    v_permlane32_swap_b32 v41, v33
    v_permlane32_swap_b32 v42, v34
    v_permlane32_swap_b32 v43, v35
    v_permlane32_swap_b32 v44, v36
    v_permlane32_swap_b32 v45, v37
    v_permlane32_swap_b32 v46, v38
    v_permlane32_swap_b32 v47, v39
    v_add_f32 v32, v32, v40
    v_add_f32 v33, v33, v41
    v_add_f32 v34, v34, v42
    v_add_f32 v35, v35, v43
    v_add_f32 v36, v36, v44
    v_add_f32 v37, v37, v45
    v_add_f32 v38, v38, v46
    v_add_f32 v39, v39, v47
    v_mov_b32 v40, v32
    v_mov_b32 v41, v33
    v_mov_b32 v42, v34
    v_mov_b32 v43, v35
    v_mov_b32 v44, v36
    v_mov_b32 v45, v37
    v_mov_b32 v46, v38
    v_mov_b32 v47, v39
    v_permlane16_swap_b32 v40, v32
    v_permlane16_swap_b32 v41, v33
    v_permlane16_swap_b32 v42, v34
    v_permlane16_swap_b32 v43, v35
    v_permlane16_swap_b32 v44, v36
    v_permlane16_swap_b32 v45, v37
    v_permlane16_swap_b32 v46, v38
    v_permlane16_swap_b32 v47, v39
    v_add_f32 v32, v32, v40
    v_add_f32 v33, v33, v41
    v_add_f32 v34, v34, v42
    v_add_f32 v35, v35, v43
    v_add_f32 v36, v36, v44
    v_add_f32 v37, v37, v45
    v_add_f32 v38, v38, v46
    v_add_f32 v39, v39, v47
    v_add_f32_dpp v40, v32, v32 row_ror:8 row_mask:0xf bank_mask:0xf
    v_add_f32_dpp v41, v33, v33 row_ror:8 row_mask:0xf bank_mask:0xf
    v_add_f32_dpp v42, v34, v34 row_ror:8 row_mask:0xf bank_mask:0xf
    v_add_f32_dpp v43, v35, v35 row_ror:8 row_mask:0xf bank_mask:0xf
    v_add_f32_dpp v44, v36, v36 row_ror:8 row_mask:0xf bank_mask:0xf
    v_add_f32_dpp v45, v37, v37 row_ror:8 row_mask:0xf bank_mask:0xf
    v_add_f32_dpp v46, v38, v38 row_ror:8 row_mask:0xf bank_mask:0xf
    v_add_f32_dpp v47, v39, v39 row_ror:8 row_mask:0xf bank_mask:0xf
    s_lshl_b32 s3, s62, 8
    v_lshl_add_u32 v26, v27, 5, s3
    ds_write_b128 v26, v[40:43]
    ds_write_b128 v26, v[44:47] offset:16
    s_waitcnt lgkmcnt(0)
    s_barrier
    v_bfe_u32 v26, v0, 4, 1
    v_lshlrev_b32 v26, 9, v26
    v_and_b32 v27, 15, v0
    v_lshl_add_u32 v26, v27, 2, v26
    v_lshrrev_b32 v27, 5, v0
    v_lshl_add_u32 v26, v27, 7, v26
    ds_read_b32 v32, v26
    ds_read_b32 v33, v26 offset:256
    ds_read_b32 v34, v26 offset:64
    ds_read_b32 v35, v26 offset:320
    v_mov_b32 v65, 0
    v_mov_b32 v67, 0
    s_lshl_b32 s3, s6, 10
    s_add_u32 s3, s3, 655360
    s_lshr_b32 s4, s6, 1
    s_lshl_b32 s4, s4, 13
    s_add_u32 s4, s4, 6144
    s_waitcnt lgkmcnt(2)
    v_add_f32 v32, v32, v33
    s_waitcnt lgkmcnt(0)
    v_add_f32 v34, v34, v35
    v_cvt_pk_bf16_f32 v28, v32, v32
    v_lshlrev_b32 v28, 16, v28
    v_sub_f32 v28, v32, v28
    v_cvt_pk_bf16_f32 v64, v32, v28
    v_cvt_pk_bf16_f32 v28, v34, v34
    v_lshlrev_b32 v28, 16, v28
    v_sub_f32 v28, v34, v28
    v_cvt_pk_bf16_f32 v66, v34, v28
    s_cmp_ge_u32 s62, 2
    s_cbranch_scc1 L_idle1
    buffer_store_dwordx4 v[64:67], v1, s[48:51], s3 offen sc1
    s_waitcnt vmcnt(0)
    s_mov_b64 exec, 1
    buffer_atomic_add v2, off, s[48:51], s4
    s_mov_b64 exec, -1
    s_waitcnt vmcnt(0)
L_idle1:
    s_barrier
L_idle2:
    v_lshlrev_b32 v26, 7, v0
    s_lshl2_add_u32 s3, s18, s62
    s_and_b32 s4, s2, 7
    s_mul_i32 s4, s4, 25
    s_add_u32 s3, s3, s4
    s_cmp_ge_u32 s3, 208
    s_cselect_b32 s4, 208, 0
    s_sub_u32 s3, s3, s4
    s_lshl_b32 s5, s3, 13
    buffer_load_dword v72, v26, s[40:43], s5 offen
    s_add_u32 s3, s3, 16
    s_cmp_ge_u32 s3, 208
    s_cselect_b32 s4, 208, 0
    s_sub_u32 s3, s3, s4
    s_lshl_b32 s5, s3, 13
    buffer_load_dword v73, v26, s[40:43], s5 offen
    s_add_u32 s3, s3, 16
L_fin:
    s_waitcnt vmcnt(0) lgkmcnt(0)
L_end:
    s_endpgm
.section .rodata,"a"
.p2align 6
.amdhsa_kernel sequential_preLN__linear_attn_block__glu_gated_glu__prompt_kernel
  .amdhsa_next_free_vgpr 512
  .amdhsa_next_free_sgpr 102
  .amdhsa_accum_offset 256
  .amdhsa_group_segment_fixed_size 0
  .amdhsa_kernarg_size 80
  .amdhsa_user_sgpr_count 2
  .amdhsa_user_sgpr_kernarg_segment_ptr 1
  .amdhsa_system_sgpr_workgroup_id_x 1
  .amdhsa_float_denorm_mode_32 3
.end_amdhsa_kernel
```
